```python
import torch

def _softmax(x, axis=-1):
    return torch.softmax(x, dim=axis)
def _gelu(x):
    return torch.nn.functional.gelu(x, approximate="tanh")
def _silu(x):
    return torch.nn.functional.silu(x)
def _sigmoid(x):
    return torch.sigmoid(x)
def _layernorm(x, axis=-1, eps=1e-5):
    m = x.mean(dim=axis, keepdim=True)
    v = x.var(dim=axis, keepdim=True, unbiased=False)
    return (x - m) / torch.sqrt(v + eps)
def _scatter_add(tgt, idx, src, axis=0):
    return tgt.clone().index_add_(axis, idx, src)
def _segment_sum(src, seg, n):
    out = torch.zeros((n,) + src.shape[1:], dtype=src.dtype)
    return out.index_add_(0, seg, src)
def _pad(x, pw):
    flat = tuple(v for pair in reversed(pw) for v in pair)
    return torch.nn.functional.pad(x, flat)

kernel_name = 'concat_heads__ssm_conv_s5__linear_attn_block__prompt'

def setup_inputs():

    _w = (lambda a: (lambda t: t.to(torch.bfloat16) if t.is_floating_point() else t)(torch.as_tensor(a)))
    def _A_setup():
        B, S, D = 1, 2048, 448
        P = D
        Lambda_re = -0.5 * (lambda _x: torch.exp(torch.as_tensor(_x)))((lambda *s: torch.randn(*s, dtype=torch.bfloat16) * 0.2)(P))
        Lambda_im = (lambda *s: torch.randn(*s, dtype=torch.bfloat16) * 0.4)(P) * 1.0
        B_re = (lambda *s: torch.randn(*s, dtype=torch.bfloat16) * 0.2)(P, D) * (D ** -0.5)
        B_im = (lambda *s: torch.randn(*s, dtype=torch.bfloat16) * 0.2)(P, D) * (D ** -0.5)
        C_re = (lambda *s: torch.randn(*s, dtype=torch.bfloat16) * 0.2)(D, P) * (P ** -0.5)
        C_im = (lambda *s: torch.randn(*s, dtype=torch.bfloat16) * 0.2)(D, P) * (P ** -0.5)
        log_dt = (lambda *s: torch.randn(*s, dtype=torch.bfloat16) * 0.2)(P) * 0.3 - 2.0
        Dskip = (lambda *s: torch.randn(*s, dtype=torch.bfloat16) * 0.05)(D)
        return {
            "x": _w((lambda *s: torch.randn(*s, dtype=torch.bfloat16) * 0.05)(B, S, D)),
            "Lambda_re": _w(Lambda_re),
            "Lambda_im": _w(Lambda_im),
            "B_re": _w(B_re),
            "B_im": _w(B_im),
            "C_re": _w(C_re),
            "C_im": _w(C_im),
            "log_dt": _w(log_dt),
            "Dskip": _w(Dskip),
        }
    _A_in = _A_setup()

    def _B_setup():
        B, S, D = 1, 2048, 448
        return {
            "x": _w((lambda *s: torch.randn(*s, dtype=torch.bfloat16) * 0.05)(B, S, D)),
            "wqkv": _w((lambda *s: torch.randn(*s, dtype=torch.bfloat16) * 0.4)(D, 3 * D)),
            "wo": _w((lambda *s: torch.randn(*s, dtype=torch.bfloat16) * 0.05)(D, D)),
        }
    _B_in = _B_setup()

    return {
        "A_x": _A_in["x"],
        "A_Lambda_re": _A_in["Lambda_re"],
        "A_Lambda_im": _A_in["Lambda_im"],
        "A_B_re": _A_in["B_re"],
        "A_B_im": _A_in["B_im"],
        "A_C_re": _A_in["C_re"],
        "A_C_im": _A_in["C_im"],
        "A_log_dt": _A_in["log_dt"],
        "A_Dskip": _A_in["Dskip"],
        "B_x": _B_in["x"],
        "B_wqkv": _B_in["wqkv"],
        "B_wo": _B_in["wo"],
    }

def reference(A_x, A_Lambda_re, A_Lambda_im, A_B_re, A_B_im, A_C_re, A_C_im, A_log_dt, A_Dskip, B_x, B_wqkv, B_wo):
    def _A_ref(x, Lambda_re, Lambda_im, B_re, B_im, C_re, C_im, log_dt, Dskip):
        Bsz, L, H = x.shape
        Lam = Lambda_re + 1j * Lambda_im
        Bmat = B_re + 1j * B_im
        Cmat = C_re + 1j * C_im
        dt = torch.exp(log_dt)
        Lam_bar = torch.exp(dt * Lam)
        B_bar = ((Lam_bar - 1.0) / Lam)[:, None] * Bmat
        Bu = torch.einsum("bld,pd->blp", x + 0j, B_bar)
        h = torch.zeros_like(Bu[:, 0, :])
        hs = []
        for t in range(L):
            h = Lam_bar[None, :] * h + Bu[:, t, :]
            hs.append(h)
        hseq = torch.stack(hs, 1)
        y = 2.0 * torch.einsum("blp,dp->bld", hseq, Cmat).real + x * Dskip[None, None, :]
        return y

    def _B_ref(x, wqkv, wo):
        B, S, D = x.shape
        H = 16; Dh = D // H
        qkv = (lambda x, *d: x.permute(*d))((x @ wqkv).reshape(B, S, 3, H, Dh), 2, 0, 3, 1, 4)
        q, k, v = qkv[0], qkv[1], qkv[2]
        phi = lambda t: torch.where(t > 0, t + 1, torch.exp(t)) + 1e-6
        pq, pk = phi(q), phi(k)
        kv = torch.einsum("bhsd,bhse->bhde", pk, v)
        z = torch.einsum("bhsd->bhd", pk)
        num = torch.einsum("bhqd,bhde->bhqe", pq, kv)
        den = torch.einsum("bhqd,bhd->bhq", pq, z)[..., None] + 1e-6
        o = num / den
        return (lambda x, *d: x.permute(*d))(o, 0, 2, 1, 3).reshape(B, S, D) @ wo

    a = _A_ref(A_x, A_Lambda_re, A_Lambda_im, A_B_re, A_B_im, A_C_re, A_C_im, A_log_dt, A_Dskip)
    b = _B_ref(B_x, B_wqkv, B_wo)
    return torch.concatenate([a, b], axis=-1)
```

```asm
; @launch grid=(256,1,1) block=(512,1,1) lds=163840
.amdgcn_target "amdgcn-amd-amdhsa--gfx950"
.text
.globl concat_heads__ssm_conv_s5__linear_attn_block__prompt_kernel
.p2align 8
.type concat_heads__ssm_conv_s5__linear_attn_block__prompt_kernel,@function
concat_heads__ssm_conv_s5__linear_attn_block__prompt_kernel:
s_cmp_ge_u32 s2, 256
s_cbranch_scc1 L_exit
s_getpc_b64 s[96:97]
s_load_dwordx16 s[64:79], s[0:1], 0
s_load_dwordx8 s[80:87], s[0:1], 64
s_load_dwordx4 s[88:91], s[0:1], 96
s_load_dwordx2 s[92:93], s[0:1], 112
s_lshr_b32 s7, s2, 3
s_mul_i32 s7, s7, 9
v_add_u32 v2, s7, v0
v_lshlrev_b32 v2, 7, v2
s_mov_b32 s3, L_codeend-concat_heads__ssm_conv_s5__linear_attn_block__prompt_kernel-128
v_cmp_gt_u32 vcc, s3, v2
v_cmp_gt_u32 s[44:45], 9, v0
s_and_b64 vcc, vcc, s[44:45]
s_and_saveexec_b64 s[42:43], vcc
s_cbranch_execz L_nocp
global_load_dword v254, v2, s[96:97]
L_nocp:
s_mov_b64 exec, s[42:43]
v_lshrrev_b32 v1, 6, v0
v_and_b32 v0, 63, v0
v_readfirstlane_b32 s6, v1
s_and_b32 s3, s2, 7
s_lshr_b32 s7, s2, 3
s_xor_b32 s3, s3, 4
s_cmp_ge_u32 s3, 4
s_cbranch_scc1 L_B
s_cmp_ge_u32 s7, 28
s_cbranch_scc1 L_H
s_mul_i32 s46, s7, 37
s_lshr_b32 s46, s46, 8
s_mul_i32 s47, s46, 7
s_sub_u32 s5, s7, s47
s_lshl_b32 s4, s3, 2
s_add_u32 s4, s4, s46
s_cmp_ge_u32 s6, 4
s_cbranch_scc1 L_AL
s_lshl_b32 s3, s5, 6
s_and_b32 s7, s6, 1
s_lshl_b32 s7, s7, 5
s_add_u32 s3, s3, s7
v_and_b32 v1, 31, v0
v_add_u32 v1, s3, v1
v_lshlrev_b32 v2, 1, v1
s_waitcnt lgkmcnt(0)
global_load_ushort v143, v2, s[66:67]
global_load_ushort v144, v2, s[68:69]
global_load_ushort v145, v2, s[78:79]
s_lshl_b32 s7, s5, 6
v_and_b32 v3, 31, v0
v_add_u32 v3, s7, v3
v_lshlrev_b32 v3, 1, v3
global_load_ushort v156, v3, s[80:81]
global_load_ushort v157, v3, s[80:81] offset:64
s_mov_b32 s50, -1
s_mov_b32 s51, 0
s_lshr_b32 s7, s6, 1
s_cmp_eq_u32 s7, 0
s_cselect_b64 s[52:53], -1, 0
v_and_b32 v1, 31, v0
v_lshrrev_b32 v2, 5, v0
v_lshrrev_b32 v3, 1, v1
v_and_b32 v3, 7, v3
s_and_b32 s3, s6, 1
s_lshl_b32 s7, s7, 13
s_lshl_b32 s3, s3, 12
s_add_u32 s3, s3, 16384
v_lshlrev_b32 v4, 7, v1
v_add_u32 v5, 0, v2
v_xor_b32 v5, v5, v3
v_lshlrev_b32 v5, 4, v5
v_add_u32 v5, v5, v4
v_add_u32 v16, s7, v5
v_add_u32 v20, s3, v5
v_add_u32 v24, 0x10000, v16
v_add_u32 v28, 0x10000, v20
v_add_u32 v196, 0x20000, v16
v_add_u32 v200, 0x20000, v20
v_add_u32 v5, 2, v2
v_xor_b32 v5, v5, v3
v_lshlrev_b32 v5, 4, v5
v_add_u32 v5, v5, v4
v_add_u32 v17, s7, v5
v_add_u32 v21, s3, v5
v_add_u32 v25, 0x10000, v17
v_add_u32 v29, 0x10000, v21
v_add_u32 v197, 0x20000, v17
v_add_u32 v201, 0x20000, v21
v_add_u32 v5, 4, v2
v_xor_b32 v5, v5, v3
v_lshlrev_b32 v5, 4, v5
v_add_u32 v5, v5, v4
v_add_u32 v18, s7, v5
v_add_u32 v22, s3, v5
v_add_u32 v26, 0x10000, v18
v_add_u32 v30, 0x10000, v22
v_add_u32 v198, 0x20000, v18
v_add_u32 v202, 0x20000, v22
v_add_u32 v5, 6, v2
v_xor_b32 v5, v5, v3
v_lshlrev_b32 v5, 4, v5
v_add_u32 v5, v5, v4
v_add_u32 v19, s7, v5
v_add_u32 v23, s3, v5
v_add_u32 v27, 0x10000, v19
v_add_u32 v31, 0x10000, v23
v_add_u32 v199, 0x20000, v19
v_add_u32 v203, 0x20000, v23
v_and_b32 v1, 31, v0
v_lshrrev_b32 v2, 5, v0
v_lshrrev_b32 v3, 4, v1
v_lshlrev_b32 v3, 5, v3
v_lshrrev_b32 v4, 2, v1
v_and_b32 v4, 3, v4
v_lshlrev_b32 v4, 3, v4
v_and_b32 v6, 3, v1
v_add_u32 v4, v4, v6
s_and_b32 s3, s6, 1
s_lshl_b32 s3, s3, 2
v_add_u32 v4, s3, v4
v_lshrrev_b32 v6, 1, v4
v_and_b32 v6, 7, v6
v_add_u32 v3, v3, v4
s_lshr_b32 s3, s6, 1
s_lshl_b32 s3, s3, 6
v_add_u32 v3, s3, v3
v_lshlrev_b32 v3, 7, v3
v_add_u32 v4, 0, v2
v_xor_b32 v4, v4, v6
v_lshlrev_b32 v4, 4, v4
v_add_u32 v192, v3, v4
v_add_u32 v4, 2, v2
v_xor_b32 v4, v4, v6
v_lshlrev_b32 v4, 4, v4
v_add_u32 v193, v3, v4
v_add_u32 v4, 4, v2
v_xor_b32 v4, v4, v6
v_lshlrev_b32 v4, 4, v4
v_add_u32 v194, v3, v4
v_add_u32 v4, 6, v2
v_xor_b32 v4, v4, v6
v_lshlrev_b32 v4, 4, v4
v_add_u32 v195, v3, v4
s_barrier
ds_read_b128 v[32:35], v24 offset:32768
ds_read_b128 v[36:39], v24 offset:36864
ds_read_b128 v[40:43], v28 offset:32768
ds_read_b128 v[44:47], v28 offset:40960
ds_read_b128 v[48:51], v25 offset:32768
ds_read_b128 v[52:55], v25 offset:36864
ds_read_b128 v[56:59], v29 offset:32768
ds_read_b128 v[60:63], v29 offset:40960
s_waitcnt lgkmcnt(4)
v_mfma_f32_32x32x16_bf16 v[64:79], v[32:35], v[40:43], 0
v_mfma_f32_32x32x16_bf16 v[80:95], v[36:39], v[40:43], 0
v_mfma_f32_32x32x16_bf16 v[96:111], v[32:35], v[44:47], 0
v_mfma_f32_32x32x16_bf16 v[112:127], v[36:39], v[44:47], 0
ds_read_b128 v[32:35], v26 offset:32768
ds_read_b128 v[36:39], v26 offset:36864
ds_read_b128 v[40:43], v30 offset:32768
ds_read_b128 v[44:47], v30 offset:40960
s_waitcnt lgkmcnt(4)
v_mfma_f32_32x32x16_bf16 v[64:79], v[48:51], v[56:59], v[64:79]
v_mfma_f32_32x32x16_bf16 v[80:95], v[52:55], v[56:59], v[80:95]
v_mfma_f32_32x32x16_bf16 v[96:111], v[48:51], v[60:63], v[96:111]
v_mfma_f32_32x32x16_bf16 v[112:127], v[52:55], v[60:63], v[112:127]
ds_read_b128 v[48:51], v27 offset:32768
ds_read_b128 v[52:55], v27 offset:36864
ds_read_b128 v[56:59], v31 offset:32768
ds_read_b128 v[60:63], v31 offset:40960
s_waitcnt lgkmcnt(4)
v_mfma_f32_32x32x16_bf16 v[64:79], v[32:35], v[40:43], v[64:79]
v_mfma_f32_32x32x16_bf16 v[80:95], v[36:39], v[40:43], v[80:95]
v_mfma_f32_32x32x16_bf16 v[96:111], v[32:35], v[44:47], v[96:111]
v_mfma_f32_32x32x16_bf16 v[112:127], v[36:39], v[44:47], v[112:127]
s_cmp_eq_u32 s5, 0
s_cbranch_scc0 LA_nx0
v_add_u32 v14, 0x10000, v192
ds_read_b128 v[160:163], v14 offset:32768
v_add_u32 v14, 0x10000, v193
ds_read_b128 v[164:167], v14 offset:32768
v_add_u32 v14, 0x10000, v194
ds_read_b128 v[168:171], v14 offset:32768
v_add_u32 v14, 0x10000, v195
ds_read_b128 v[172:175], v14 offset:32768
LA_nx0:
s_waitcnt lgkmcnt(0)
s_barrier
ds_read_b128 v[32:35], v196 offset:0
ds_read_b128 v[36:39], v196 offset:4096
ds_read_b128 v[40:43], v200 offset:0
ds_read_b128 v[44:47], v200 offset:8192
v_mfma_f32_32x32x16_bf16 v[64:79], v[48:51], v[56:59], v[64:79]
v_mfma_f32_32x32x16_bf16 v[80:95], v[52:55], v[56:59], v[80:95]
v_mfma_f32_32x32x16_bf16 v[96:111], v[48:51], v[60:63], v[96:111]
v_mfma_f32_32x32x16_bf16 v[112:127], v[52:55], v[60:63], v[112:127]
ds_read_b128 v[48:51], v197 offset:0
ds_read_b128 v[52:55], v197 offset:4096
ds_read_b128 v[56:59], v201 offset:0
ds_read_b128 v[60:63], v201 offset:8192
s_waitcnt lgkmcnt(4)
v_mfma_f32_32x32x16_bf16 v[64:79], v[32:35], v[40:43], v[64:79]
s_waitcnt vmcnt(0)
v_lshlrev_b32 v143, 16, v143
v_lshlrev_b32 v144, 16, v144
v_lshlrev_b32 v145, 16, v145
v_mfma_f32_32x32x16_bf16 v[80:95], v[36:39], v[40:43], v[80:95]
v_mul_f32 v145, 0x3fb8aa3b, v145
v_exp_f32 v145, v145
s_nop 0
v_cvt_pk_bf16_f32 v145, v145, v145
v_mfma_f32_32x32x16_bf16 v[96:111], v[32:35], v[44:47], v[96:111]
v_lshlrev_b32 v145, 16, v145
v_mul_f32 v146, v145, v143
v_mul_f32 v147, v145, v144
v_mul_f32 v146, 0x3fb8aa3b, v146
v_mfma_f32_32x32x16_bf16 v[112:127], v[36:39], v[44:47], v[112:127]
v_exp_f32 v146, v146
v_mul_f32 v147, 0x3e22f983, v147
v_fract_f32 v147, v147
v_cos_f32 v148, v147
ds_read_b128 v[32:35], v198 offset:0
ds_read_b128 v[36:39], v198 offset:4096
ds_read_b128 v[40:43], v202 offset:0
ds_read_b128 v[44:47], v202 offset:8192
s_waitcnt lgkmcnt(4)
v_mfma_f32_32x32x16_bf16 v[64:79], v[48:51], v[56:59], v[64:79]
v_sin_f32 v149, v147
s_nop 0
v_mul_f32 v128, v146, v148
v_mul_f32 v129, v146, v149
v_mfma_f32_32x32x16_bf16 v[80:95], v[52:55], v[56:59], v[80:95]
v_add_f32 v146, -1.0, v128
v_mul_f32 v147, v143, v143
v_fma_f32 v147, v144, v144, v147
v_rcp_f32 v147, v147
v_mfma_f32_32x32x16_bf16 v[96:111], v[48:51], v[60:63], v[96:111]
v_mul_f32 v148, v146, v143
v_fma_f32 v148, v129, v144, v148
v_mul_f32 v149, v129, v143
v_fma_f32 v149, -v146, v144, v149
v_mfma_f32_32x32x16_bf16 v[112:127], v[52:55], v[60:63], v[112:127]
v_add_f32 v147, v147, v147
v_mul_f32 v130, v148, v147
v_mul_f32 v131, v149, v147
v_mul_f32 v142, v128, v128
ds_read_b128 v[48:51], v199 offset:0
ds_read_b128 v[52:55], v199 offset:4096
ds_read_b128 v[56:59], v203 offset:0
ds_read_b128 v[60:63], v203 offset:8192
s_waitcnt lgkmcnt(4)
v_mfma_f32_32x32x16_bf16 v[64:79], v[32:35], v[40:43], v[64:79]
v_mul_f32 v143, v128, v129
v_fma_f32 v142, -v129, v129, v142
v_add_f32 v143, v143, v143
v_mul_f32 v144, v142, v142
v_mfma_f32_32x32x16_bf16 v[80:95], v[36:39], v[40:43], v[80:95]
v_mul_f32 v145, v142, v143
v_fma_f32 v144, -v143, v143, v144
v_add_f32 v145, v145, v145
v_mul_f32 v142, v144, v144
v_mfma_f32_32x32x16_bf16 v[96:111], v[32:35], v[44:47], v[96:111]
v_mul_f32 v143, v144, v145
v_fma_f32 v142, -v145, v145, v142
v_add_f32 v143, v143, v143
v_mul_f32 v132, v142, v142
v_mfma_f32_32x32x16_bf16 v[112:127], v[36:39], v[44:47], v[112:127]
v_mul_f32 v133, v142, v143
v_fma_f32 v132, -v143, v143, v132
v_add_f32 v133, v133, v133
v_mul_f32 v142, v132, v132
s_cmp_eq_u32 s5, 1
s_cbranch_scc0 LA_nx1
v_add_u32 v14, 0x20000, v192
ds_read_b128 v[160:163], v14 offset:0
v_add_u32 v14, 0x20000, v193
ds_read_b128 v[164:167], v14 offset:0
v_add_u32 v14, 0x20000, v194
ds_read_b128 v[168:171], v14 offset:0
v_add_u32 v14, 0x20000, v195
ds_read_b128 v[172:175], v14 offset:0
LA_nx1:
s_waitcnt lgkmcnt(0)
s_barrier
ds_read_b128 v[32:35], v16 offset:0
ds_read_b128 v[36:39], v16 offset:4096
ds_read_b128 v[40:43], v20 offset:0
ds_read_b128 v[44:47], v20 offset:8192
v_mfma_f32_32x32x16_bf16 v[64:79], v[48:51], v[56:59], v[64:79]
v_mul_f32 v143, v132, v133
v_fma_f32 v142, -v133, v133, v142
v_add_f32 v143, v143, v143
v_mul_f32 v144, v142, v142
v_mfma_f32_32x32x16_bf16 v[80:95], v[52:55], v[56:59], v[80:95]
v_mul_f32 v145, v142, v143
v_fma_f32 v144, -v143, v143, v144
v_add_f32 v145, v145, v145
v_mul_f32 v134, v144, v144
v_mfma_f32_32x32x16_bf16 v[96:111], v[48:51], v[60:63], v[96:111]
v_mul_f32 v135, v144, v145
v_fma_f32 v134, -v145, v145, v134
v_add_f32 v135, v135, v135
v_mul_f32 v140, v134, v134
v_mfma_f32_32x32x16_bf16 v[112:127], v[52:55], v[60:63], v[112:127]
v_mul_f32 v141, v134, v135
v_fma_f32 v140, -v135, v135, v140
v_add_f32 v141, v141, v141
v_cndmask_b32 v146, v142, 1.0, s[50:51]
ds_read_b128 v[48:51], v17 offset:0
ds_read_b128 v[52:55], v17 offset:4096
ds_read_b128 v[56:59], v21 offset:0
ds_read_b128 v[60:63], v21 offset:8192
s_waitcnt lgkmcnt(4)
v_mfma_f32_32x32x16_bf16 v[64:79], v[32:35], v[40:43], v[64:79]
v_cndmask_b32 v147, v143, 0, s[50:51]
v_cndmask_b32 v148, v144, 1.0, s[52:53]
v_cndmask_b32 v149, v145, 0, s[52:53]
v_mul_f32 v136, v146, v148
v_mfma_f32_32x32x16_bf16 v[80:95], v[36:39], v[40:43], v[80:95]
v_mul_f32 v137, v146, v149
v_fma_f32 v136, -v147, v149, v136
v_fma_f32 v137, v147, v148, v137
v_mul_f32 v138, v136, v132
v_mfma_f32_32x32x16_bf16 v[96:111], v[32:35], v[44:47], v[96:111]
v_mul_f32 v139, v136, v133
v_fma_f32 v138, -v137, v133, v138
v_fma_f32 v139, v137, v132, v139
v_and_b32 v1, 31, v0
v_mfma_f32_32x32x16_bf16 v[112:127], v[36:39], v[44:47], v[112:127]
v_lshrrev_b32 v2, 5, v0
s_mov_b32 s12, s88
s_mov_b32 s13, s89
s_mov_b32 s14, 0x700000
ds_read_b128 v[32:35], v18 offset:0
ds_read_b128 v[36:39], v18 offset:4096
ds_read_b128 v[40:43], v22 offset:0
ds_read_b128 v[44:47], v22 offset:8192
s_waitcnt lgkmcnt(4)
v_mfma_f32_32x32x16_bf16 v[64:79], v[48:51], v[56:59], v[64:79]
s_mov_b32 s15, 0x20000
v_lshrrev_b32 v7, 1, v1
v_and_b32 v7, 7, v7
v_lshlrev_b32 v8, 7, v1
v_mfma_f32_32x32x16_bf16 v[80:95], v[52:55], v[56:59], v[80:95]
v_add_u32 v9, 0, v2
v_xor_b32 v9, v9, v7
v_lshlrev_b32 v9, 4, v9
v_add_u32 v142, v9, v8
v_mfma_f32_32x32x16_bf16 v[96:111], v[48:51], v[60:63], v[96:111]
v_add_u32 v146, 57344, v142
v_add_u32 v9, 2, v2
v_xor_b32 v9, v9, v7
v_lshlrev_b32 v9, 4, v9
v_mfma_f32_32x32x16_bf16 v[112:127], v[52:55], v[60:63], v[112:127]
v_add_u32 v143, v9, v8
v_add_u32 v147, 57344, v143
v_add_u32 v9, 4, v2
v_xor_b32 v9, v9, v7
ds_read_b128 v[48:51], v19 offset:0
ds_read_b128 v[52:55], v19 offset:4096
ds_read_b128 v[56:59], v23 offset:0
ds_read_b128 v[60:63], v23 offset:8192
s_waitcnt lgkmcnt(4)
v_mfma_f32_32x32x16_bf16 v[64:79], v[32:35], v[40:43], v[64:79]
v_lshlrev_b32 v9, 4, v9
v_add_u32 v144, v9, v8
v_add_u32 v148, 57344, v144
v_add_u32 v9, 6, v2
v_mfma_f32_32x32x16_bf16 v[80:95], v[36:39], v[40:43], v[80:95]
v_xor_b32 v9, v9, v7
v_lshlrev_b32 v9, 4, v9
v_add_u32 v145, v9, v8
v_add_u32 v149, 57344, v145
v_mfma_f32_32x32x16_bf16 v[96:111], v[32:35], v[44:47], v[96:111]
v_lshlrev_b32 v9, 3, v2
v_sub_u32 v9, v1, v9
v_ashrrev_i32 v9, 1, v9
v_and_b32 v10, 1, v1
v_mfma_f32_32x32x16_bf16 v[112:127], v[36:39], v[44:47], v[112:127]
v_lshlrev_b32 v10, 4, v10
v_lshlrev_b32 v11, v10, v156
v_lshlrev_b32 v12, v10, v157
v_cmp_eq_u32 s[44:45], 0, v9
s_cmp_eq_u32 s5, 2
s_cbranch_scc0 LA_nx2
ds_read_b128 v[160:163], v192 offset:0
ds_read_b128 v[164:167], v193 offset:0
ds_read_b128 v[168:171], v194 offset:0
ds_read_b128 v[172:175], v195 offset:0
LA_nx2:
s_waitcnt lgkmcnt(0)
s_barrier
ds_read_b128 v[32:35], v16 offset:32768
ds_read_b128 v[36:39], v16 offset:36864
ds_read_b128 v[40:43], v20 offset:32768
ds_read_b128 v[44:47], v20 offset:40960
v_mfma_f32_32x32x16_bf16 v[64:79], v[48:51], v[56:59], v[64:79]
v_cndmask_b32 v176, 0, v11, s[44:45]
v_cndmask_b32 v184, 0, v12, s[44:45]
v_cmp_eq_u32 s[42:43], 1, v9
s_nop 1
v_cndmask_b32 v177, 0, v11, s[42:43]
v_mfma_f32_32x32x16_bf16 v[80:95], v[52:55], v[56:59], v[80:95]
v_cndmask_b32 v185, 0, v12, s[42:43]
v_cmp_eq_u32 s[44:45], 2, v9
s_nop 1
v_cndmask_b32 v178, 0, v11, s[44:45]
v_cndmask_b32 v186, 0, v12, s[44:45]
v_mfma_f32_32x32x16_bf16 v[96:111], v[48:51], v[60:63], v[96:111]
v_cmp_eq_u32 s[42:43], 3, v9
s_nop 1
v_cndmask_b32 v179, 0, v11, s[42:43]
v_cndmask_b32 v187, 0, v12, s[42:43]
v_cmp_eq_u32 s[44:45], 8, v9
v_mfma_f32_32x32x16_bf16 v[112:127], v[52:55], v[60:63], v[112:127]
s_nop 0
v_cndmask_b32 v180, 0, v11, s[44:45]
v_cndmask_b32 v188, 0, v12, s[44:45]
v_cmp_eq_u32 s[42:43], 9, v9
s_nop 1
v_cndmask_b32 v181, 0, v11, s[42:43]
ds_read_b128 v[48:51], v17 offset:32768
ds_read_b128 v[52:55], v17 offset:36864
ds_read_b128 v[56:59], v21 offset:32768
ds_read_b128 v[60:63], v21 offset:40960
s_waitcnt lgkmcnt(4)
v_mfma_f32_32x32x16_bf16 v[64:79], v[32:35], v[40:43], v[64:79]
v_cndmask_b32 v189, 0, v12, s[42:43]
v_cmp_eq_u32 s[44:45], 10, v9
s_nop 1
v_cndmask_b32 v182, 0, v11, s[44:45]
v_cndmask_b32 v190, 0, v12, s[44:45]
v_mfma_f32_32x32x16_bf16 v[80:95], v[36:39], v[40:43], v[80:95]
v_cmp_eq_u32 s[42:43], 11, v9
s_nop 1
v_cndmask_b32 v183, 0, v11, s[42:43]
v_cndmask_b32 v191, 0, v12, s[42:43]
s_mul_i32 s3, s6, 8704
v_mfma_f32_32x32x16_bf16 v[96:111], v[32:35], v[44:47], v[96:111]
s_add_u32 s3, s3, 114688
v_mul_u32_u24 v3, 272, v1
v_lshlrev_b32 v4, 4, v2
v_add_u32 v3, v3, v4
v_mfma_f32_32x32x16_bf16 v[112:127], v[36:39], v[44:47], v[112:127]
v_add_u32 v204, s3, v3
v_lshrrev_b32 v5, 4, v0
v_mul_u32_u24 v6, 272, v5
v_and_b32 v7, 15, v0
ds_read_b128 v[32:35], v18 offset:32768
ds_read_b128 v[36:39], v18 offset:36864
ds_read_b128 v[40:43], v22 offset:32768
ds_read_b128 v[44:47], v22 offset:40960
s_waitcnt lgkmcnt(4)
v_mfma_f32_32x32x16_bf16 v[64:79], v[48:51], v[56:59], v[64:79]
v_lshlrev_b32 v7, 4, v7
v_add_u32 v6, v6, v7
v_add_u32 v205, s3, v6
v_and_b32 v8, 1, v5
v_mfma_f32_32x32x16_bf16 v[80:95], v[52:55], v[56:59], v[80:95]
v_lshlrev_b32 v8, 4, v8
v_add_u32 v8, v8, v2
v_mul_u32_u24 v8, 3584, v8
v_add_u32 v206, v8, v7
v_mfma_f32_32x32x16_bf16 v[96:111], v[48:51], v[60:63], v[96:111]
s_lshl_b32 s3, s4, 7
s_lshl_b32 s7, s6, 5
s_add_u32 s3, s3, s7
s_mul_i32 s3, s3, 3584
v_mfma_f32_32x32x16_bf16 v[112:127], v[52:55], v[60:63], v[112:127]
s_lshl_b32 s7, s5, 8
s_add_u32 s58, s3, s7
s_lshl_b32 s3, s4, 2
s_add_u32 s3, s3, s6
ds_read_b128 v[48:51], v19 offset:32768
ds_read_b128 v[52:55], v19 offset:36864
ds_read_b128 v[56:59], v23 offset:32768
ds_read_b128 v[60:63], v23 offset:40960
s_waitcnt lgkmcnt(4)
v_mfma_f32_32x32x16_bf16 v[64:79], v[32:35], v[40:43], v[64:79]
s_mul_i32 s3, s3, 57344
s_add_u32 s3, s3, 0x400000
s_mov_b32 s47, s5
s_lshl_b32 s7, s47, 13
v_mfma_f32_32x32x16_bf16 v[80:95], v[36:39], v[40:43], v[80:95]
s_add_u32 s32, s3, s7
s_add_u32 s47, s47, 1
s_cmp_eq_u32 s47, 7
s_cselect_b32 s47, 0, s47
s_lshl_b32 s7, s47, 13
s_add_u32 s33, s3, s7
v_mfma_f32_32x32x16_bf16 v[96:111], v[32:35], v[44:47], v[96:111]
s_add_u32 s47, s47, 1
s_cmp_eq_u32 s47, 7
s_cselect_b32 s47, 0, s47
s_lshl_b32 s7, s47, 13
s_add_u32 s34, s3, s7
s_add_u32 s47, s47, 1
s_cmp_eq_u32 s47, 7
s_cselect_b32 s47, 0, s47
v_mfma_f32_32x32x16_bf16 v[112:127], v[36:39], v[44:47], v[112:127]
s_lshl_b32 s7, s47, 13
s_add_u32 s35, s3, s7
s_add_u32 s47, s47, 1
s_cmp_eq_u32 s47, 7
s_cselect_b32 s47, 0, s47
s_lshl_b32 s7, s47, 13
s_cmp_eq_u32 s5, 3
s_cbranch_scc0 LA_nx3
ds_read_b128 v[160:163], v192 offset:32768
ds_read_b128 v[164:167], v193 offset:32768
ds_read_b128 v[168:171], v194 offset:32768
ds_read_b128 v[172:175], v195 offset:32768
LA_nx3:
s_waitcnt lgkmcnt(0)
s_barrier
ds_read_b128 v[32:35], v24 offset:0
ds_read_b128 v[36:39], v24 offset:4096
ds_read_b128 v[40:43], v28 offset:0
ds_read_b128 v[44:47], v28 offset:8192
v_mfma_f32_32x32x16_bf16 v[64:79], v[48:51], v[56:59], v[64:79]
s_add_u32 s36, s3, s7
s_add_u32 s47, s47, 1
s_cmp_eq_u32 s47, 7
s_cselect_b32 s47, 0, s47
s_lshl_b32 s7, s47, 13
s_add_u32 s37, s3, s7
v_mfma_f32_32x32x16_bf16 v[80:95], v[52:55], v[56:59], v[80:95]
s_add_u32 s47, s47, 1
s_cmp_eq_u32 s47, 7
s_cselect_b32 s47, 0, s47
s_lshl_b32 s7, s47, 13
s_add_u32 s38, s3, s7
s_add_u32 s47, s47, 1
s_cmp_eq_u32 s47, 7
s_cselect_b32 s47, 0, s47
v_mfma_f32_32x32x16_bf16 v[96:111], v[48:51], v[60:63], v[96:111]
s_mul_i32 s3, s6, 9216
s_add_u32 s3, s3, 119808
v_and_b32 v1, 31, v0
v_lshrrev_b32 v2, 5, v0
v_mfma_f32_32x32x16_bf16 v[112:127], v[52:55], v[60:63], v[112:127]
v_mul_u32_u24 v3, 144, v1
v_lshlrev_b32 v4, 6, v2
v_add_u32 v3, v3, v4
v_add_u32 v152, s3, v3
ds_read_b128 v[48:51], v25 offset:0
ds_read_b128 v[52:55], v25 offset:4096
ds_read_b128 v[56:59], v29 offset:0
ds_read_b128 v[60:63], v29 offset:8192
s_waitcnt lgkmcnt(4)
v_mfma_f32_32x32x16_bf16 v[64:79], v[32:35], v[40:43], v[64:79]
v_lshrrev_b32 v4, 4, v0
v_and_b32 v5, 1, v4
v_lshrrev_b32 v4, 1, v4
v_and_b32 v6, 15, v0
v_mfma_f32_32x32x16_bf16 v[80:95], v[36:39], v[40:43], v[80:95]
v_lshrrev_b32 v6, 2, v6
v_and_b32 v7, 3, v0
v_lshlrev_b32 v4, 3, v4
v_add_u32 v4, v4, v6
v_mfma_f32_32x32x16_bf16 v[96:111], v[32:35], v[44:47], v[96:111]
v_mul_u32_u24 v4, 144, v4
v_lshlrev_b32 v5, 5, v5
v_lshlrev_b32 v7, 3, v7
v_add_u32 v4, v4, v5
v_mfma_f32_32x32x16_bf16 v[112:127], v[36:39], v[44:47], v[112:127]
v_add_u32 v4, v4, v7
v_add_u32 v153, s3, v4
s_mov_b32 s16, s92
s_mov_b32 s17, s93
ds_read_b128 v[32:35], v26 offset:0
ds_read_b128 v[36:39], v26 offset:4096
ds_read_b128 v[40:43], v30 offset:0
ds_read_b128 v[44:47], v30 offset:8192
s_waitcnt lgkmcnt(4)
v_mfma_f32_32x32x16_bf16 v[64:79], v[48:51], v[56:59], v[64:79]
s_mov_b32 s18, 0x800000
s_mov_b32 s19, 0x20000
s_lshr_b32 s7, s6, 1
s_lshl_b32 s7, s7, 1
v_mfma_f32_32x32x16_bf16 v[80:95], v[52:55], v[56:59], v[80:95]
s_lshl_b32 s3, s4, 2
s_add_u32 s3, s3, s7
s_mul_i32 s3, s3, 56
s_lshl_b32 s7, s5, 3
v_mfma_f32_32x32x16_bf16 v[96:111], v[48:51], v[60:63], v[96:111]
s_add_u32 s3, s3, s7
s_and_b32 s7, s6, 1
s_lshl_b32 s7, s7, 1
s_add_u32 s3, s3, s7
v_mfma_f32_32x32x16_bf16 v[112:127], v[52:55], v[60:63], v[112:127]
s_lshl_b32 s3, s3, 10
s_add_u32 s44, s3, 0x400000
v_lshlrev_b32 v154, 4, v0
s_mul_i32 s3, s4, 28
ds_read_b128 v[48:51], v27 offset:0
ds_read_b128 v[52:55], v27 offset:4096
ds_read_b128 v[56:59], v31 offset:0
ds_read_b128 v[60:63], v31 offset:8192
s_waitcnt lgkmcnt(4)
v_mfma_f32_32x32x16_bf16 v[64:79], v[32:35], v[40:43], v[64:79]
s_lshl_b32 s7, s5, 2
s_add_u32 s3, s3, s7
s_add_u32 s3, s3, s6
s_lshl_b32 s3, s3, 7
v_mfma_f32_32x32x16_bf16 v[80:95], v[36:39], v[40:43], v[80:95]
s_add_u32 s55, s3, 0x30000
v_and_b32 v1, 31, v0
v_lshrrev_b32 v2, 5, v0
s_and_b32 s3, s6, 1
v_mfma_f32_32x32x16_bf16 v[96:111], v[32:35], v[44:47], v[96:111]
s_lshl_b32 s3, s3, 8
s_add_u32 s3, s3, 114688
v_lshlrev_b32 v3, 3, v1
v_add_u32 v158, s3, v3
v_mfma_f32_32x32x16_bf16 v[112:127], v[36:39], v[44:47], v[112:127]
s_lshr_b32 s7, s6, 1
s_lshl_b32 s7, s7, 11
v_lshlrev_b32 v4, 10, v2
v_add_u32 v4, v4, v158
s_cmp_eq_u32 s5, 4
s_cbranch_scc0 LA_nx4
v_add_u32 v14, 0x10000, v192
ds_read_b128 v[160:163], v14 offset:0
v_add_u32 v14, 0x10000, v193
ds_read_b128 v[164:167], v14 offset:0
v_add_u32 v14, 0x10000, v194
ds_read_b128 v[168:171], v14 offset:0
v_add_u32 v14, 0x10000, v195
ds_read_b128 v[172:175], v14 offset:0
LA_nx4:
s_waitcnt lgkmcnt(0)
s_barrier
ds_read_b128 v[32:35], v24 offset:32768
ds_read_b128 v[36:39], v24 offset:36864
ds_read_b128 v[40:43], v28 offset:32768
ds_read_b128 v[44:47], v28 offset:40960
v_mfma_f32_32x32x16_bf16 v[64:79], v[48:51], v[56:59], v[64:79]
v_add_u32 v159, s7, v4
s_lshl_b32 s3, s5, 6
s_and_b32 s7, s6, 1
s_lshl_b32 s7, s7, 5
v_mfma_f32_32x32x16_bf16 v[80:95], v[52:55], v[56:59], v[80:95]
s_add_u32 s3, s3, s7
s_mul_i32 s7, s4, 448
s_add_u32 s3, s3, s7
v_add_u32 v6, s3, v1
v_mfma_f32_32x32x16_bf16 v[96:111], v[48:51], v[60:63], v[96:111]
v_lshlrev_b32 v155, 3, v6
v_add_u32 v5, 1, v2
v_mul_u32_u24 v5, 3584, v5
v_sub_u32 v150, v155, v5
v_mfma_f32_32x32x16_bf16 v[112:127], v[52:55], v[60:63], v[112:127]
s_mov_b32 s20, s92
s_mov_b32 s21, s93
s_mov_b32 s22, 0xe000
s_mov_b32 s23, 0x20000
ds_read_b128 v[48:51], v25 offset:32768
ds_read_b128 v[52:55], v25 offset:36864
ds_read_b128 v[56:59], v29 offset:32768
ds_read_b128 v[60:63], v29 offset:40960
s_waitcnt lgkmcnt(4)
v_mfma_f32_32x32x16_bf16 v[64:79], v[32:35], v[40:43], v[64:79]
s_add_u32 s3, s4, 1
v_sub_u32 v7, s3, v2
v_lshrrev_b32 v151, 1, v7
v_mfma_f32_32x32x16_bf16 v[80:95], v[36:39], v[40:43], v[80:95]
v_mfma_f32_32x32x16_bf16 v[96:111], v[32:35], v[44:47], v[96:111]
v_mfma_f32_32x32x16_bf16 v[112:127], v[36:39], v[44:47], v[112:127]
ds_read_b128 v[32:35], v26 offset:32768
ds_read_b128 v[36:39], v26 offset:36864
ds_read_b128 v[40:43], v30 offset:32768
ds_read_b128 v[44:47], v30 offset:40960
s_waitcnt lgkmcnt(4)
v_mfma_f32_32x32x16_bf16 v[64:79], v[48:51], v[56:59], v[64:79]
v_mfma_f32_32x32x16_bf16 v[80:95], v[52:55], v[56:59], v[80:95]
v_mfma_f32_32x32x16_bf16 v[96:111], v[48:51], v[60:63], v[96:111]
v_mfma_f32_32x32x16_bf16 v[112:127], v[52:55], v[60:63], v[112:127]
ds_read_b128 v[48:51], v27 offset:32768
ds_read_b128 v[52:55], v27 offset:36864
ds_read_b128 v[56:59], v31 offset:32768
ds_read_b128 v[60:63], v31 offset:40960
s_waitcnt lgkmcnt(4)
v_mfma_f32_32x32x16_bf16 v[64:79], v[32:35], v[40:43], v[64:79]
v_mfma_f32_32x32x16_bf16 v[80:95], v[36:39], v[40:43], v[80:95]
v_mfma_f32_32x32x16_bf16 v[96:111], v[32:35], v[44:47], v[96:111]
v_mfma_f32_32x32x16_bf16 v[112:127], v[36:39], v[44:47], v[112:127]
s_cmp_eq_u32 s5, 5
s_cbranch_scc0 LA_nx5
v_add_u32 v14, 0x10000, v192
ds_read_b128 v[160:163], v14 offset:32768
v_add_u32 v14, 0x10000, v193
ds_read_b128 v[164:167], v14 offset:32768
v_add_u32 v14, 0x10000, v194
ds_read_b128 v[168:171], v14 offset:32768
v_add_u32 v14, 0x10000, v195
ds_read_b128 v[172:175], v14 offset:32768
LA_nx5:
s_waitcnt lgkmcnt(0)
s_barrier
ds_read_b128 v[32:35], v196 offset:0
ds_read_b128 v[36:39], v196 offset:4096
ds_read_b128 v[40:43], v200 offset:0
ds_read_b128 v[44:47], v200 offset:8192
v_mfma_f32_32x32x16_bf16 v[64:79], v[48:51], v[56:59], v[64:79]
v_mfma_f32_32x32x16_bf16 v[80:95], v[52:55], v[56:59], v[80:95]
v_mfma_f32_32x32x16_bf16 v[96:111], v[48:51], v[60:63], v[96:111]
v_mfma_f32_32x32x16_bf16 v[112:127], v[52:55], v[60:63], v[112:127]
ds_read_b128 v[48:51], v197 offset:0
ds_read_b128 v[52:55], v197 offset:4096
ds_read_b128 v[56:59], v201 offset:0
ds_read_b128 v[60:63], v201 offset:8192
s_waitcnt lgkmcnt(4)
v_mfma_f32_32x32x16_bf16 v[64:79], v[32:35], v[40:43], v[64:79]
v_mfma_f32_32x32x16_bf16 v[80:95], v[36:39], v[40:43], v[80:95]
v_mfma_f32_32x32x16_bf16 v[96:111], v[32:35], v[44:47], v[96:111]
v_mfma_f32_32x32x16_bf16 v[112:127], v[36:39], v[44:47], v[112:127]
ds_read_b128 v[32:35], v198 offset:0
ds_read_b128 v[36:39], v198 offset:4096
ds_read_b128 v[40:43], v202 offset:0
ds_read_b128 v[44:47], v202 offset:8192
s_waitcnt lgkmcnt(4)
v_mfma_f32_32x32x16_bf16 v[64:79], v[48:51], v[56:59], v[64:79]
v_mfma_f32_32x32x16_bf16 v[80:95], v[52:55], v[56:59], v[80:95]
v_mfma_f32_32x32x16_bf16 v[96:111], v[48:51], v[60:63], v[96:111]
v_mfma_f32_32x32x16_bf16 v[112:127], v[52:55], v[60:63], v[112:127]
ds_read_b128 v[48:51], v199 offset:0
ds_read_b128 v[52:55], v199 offset:4096
ds_read_b128 v[56:59], v203 offset:0
ds_read_b128 v[60:63], v203 offset:8192
s_waitcnt lgkmcnt(4)
v_mfma_f32_32x32x16_bf16 v[64:79], v[32:35], v[40:43], v[64:79]
v_mfma_f32_32x32x16_bf16 v[80:95], v[36:39], v[40:43], v[80:95]
v_mfma_f32_32x32x16_bf16 v[96:111], v[32:35], v[44:47], v[96:111]
v_mfma_f32_32x32x16_bf16 v[112:127], v[36:39], v[44:47], v[112:127]
s_cmp_eq_u32 s5, 6
s_cbranch_scc0 LA_nx6
v_add_u32 v14, 0x20000, v192
ds_read_b128 v[160:163], v14 offset:0
v_add_u32 v14, 0x20000, v193
ds_read_b128 v[164:167], v14 offset:0
v_add_u32 v14, 0x20000, v194
ds_read_b128 v[168:171], v14 offset:0
v_add_u32 v14, 0x20000, v195
ds_read_b128 v[172:175], v14 offset:0
LA_nx6:
s_waitcnt lgkmcnt(0)
v_mfma_f32_32x32x16_bf16 v[64:79], v[48:51], v[56:59], v[64:79]
v_mfma_f32_32x32x16_bf16 v[80:95], v[52:55], v[56:59], v[80:95]
v_mfma_f32_32x32x16_bf16 v[96:111], v[48:51], v[60:63], v[96:111]
v_mfma_f32_32x32x16_bf16 v[112:127], v[52:55], v[60:63], v[112:127]
v_mfma_f32_32x32x16_bf16 v[220:235], v[176:179], v[160:163], 0
v_mfma_f32_32x32x16_bf16 v[220:235], v[180:183], v[164:167], v[220:235]
v_mfma_f32_32x32x16_bf16 v[236:251], v[184:187], v[168:171], 0
v_mfma_f32_32x32x16_bf16 v[236:251], v[188:191], v[172:175], v[236:251]
s_nop 4
v_pk_fma_f32 v[160:161], v[128:129], v[64:65], v[66:67] op_sel:[0,0,0] op_sel_hi:[0,1,1]
s_nop 0
v_pk_fma_f32 v[162:163], v[128:129], v[96:97], v[98:99] op_sel:[0,0,0] op_sel_hi:[0,1,1]
v_pk_fma_f32 v[160:161], v[128:129], v[96:97], v[160:161] op_sel:[1,0,0] op_sel_hi:[1,1,1] neg_lo:[1,0,0] neg_hi:[1,0,0]
v_pk_fma_f32 v[162:163], v[128:129], v[64:65], v[162:163] op_sel:[1,0,0] op_sel_hi:[1,1,1]
v_pk_fma_f32 v[164:165], v[128:129], v[160:161], v[68:69] op_sel:[0,0,0] op_sel_hi:[0,1,1]
v_pk_fma_f32 v[166:167], v[128:129], v[162:163], v[100:101] op_sel:[0,0,0] op_sel_hi:[0,1,1]
v_pk_fma_f32 v[164:165], v[128:129], v[162:163], v[164:165] op_sel:[1,0,0] op_sel_hi:[1,1,1] neg_lo:[1,0,0] neg_hi:[1,0,0]
v_pk_fma_f32 v[166:167], v[128:129], v[160:161], v[166:167] op_sel:[1,0,0] op_sel_hi:[1,1,1]
v_pk_fma_f32 v[160:161], v[128:129], v[164:165], v[70:71] op_sel:[0,0,0] op_sel_hi:[0,1,1]
v_pk_fma_f32 v[162:163], v[128:129], v[166:167], v[102:103] op_sel:[0,0,0] op_sel_hi:[0,1,1]
v_pk_fma_f32 v[160:161], v[128:129], v[166:167], v[160:161] op_sel:[1,0,0] op_sel_hi:[1,1,1] neg_lo:[1,0,0] neg_hi:[1,0,0]
v_pk_fma_f32 v[162:163], v[128:129], v[164:165], v[162:163] op_sel:[1,0,0] op_sel_hi:[1,1,1]
v_pk_fma_f32 v[164:165], v[128:129], v[160:161], v[72:73] op_sel:[0,0,0] op_sel_hi:[0,1,1]
v_pk_fma_f32 v[166:167], v[128:129], v[162:163], v[104:105] op_sel:[0,0,0] op_sel_hi:[0,1,1]
v_pk_fma_f32 v[164:165], v[128:129], v[162:163], v[164:165] op_sel:[1,0,0] op_sel_hi:[1,1,1] neg_lo:[1,0,0] neg_hi:[1,0,0]
v_pk_fma_f32 v[166:167], v[128:129], v[160:161], v[166:167] op_sel:[1,0,0] op_sel_hi:[1,1,1]
v_pk_fma_f32 v[160:161], v[128:129], v[164:165], v[74:75] op_sel:[0,0,0] op_sel_hi:[0,1,1]
v_pk_fma_f32 v[162:163], v[128:129], v[166:167], v[106:107] op_sel:[0,0,0] op_sel_hi:[0,1,1]
v_pk_fma_f32 v[160:161], v[128:129], v[166:167], v[160:161] op_sel:[1,0,0] op_sel_hi:[1,1,1] neg_lo:[1,0,0] neg_hi:[1,0,0]
v_pk_fma_f32 v[162:163], v[128:129], v[164:165], v[162:163] op_sel:[1,0,0] op_sel_hi:[1,1,1]
v_pk_fma_f32 v[164:165], v[128:129], v[160:161], v[76:77] op_sel:[0,0,0] op_sel_hi:[0,1,1]
v_pk_fma_f32 v[166:167], v[128:129], v[162:163], v[108:109] op_sel:[0,0,0] op_sel_hi:[0,1,1]
v_pk_fma_f32 v[164:165], v[128:129], v[162:163], v[164:165] op_sel:[1,0,0] op_sel_hi:[1,1,1] neg_lo:[1,0,0] neg_hi:[1,0,0]
v_pk_fma_f32 v[166:167], v[128:129], v[160:161], v[166:167] op_sel:[1,0,0] op_sel_hi:[1,1,1]
v_pk_fma_f32 v[160:161], v[128:129], v[164:165], v[78:79] op_sel:[0,0,0] op_sel_hi:[0,1,1]
v_pk_fma_f32 v[162:163], v[128:129], v[166:167], v[110:111] op_sel:[0,0,0] op_sel_hi:[0,1,1]
v_pk_fma_f32 v[160:161], v[128:129], v[166:167], v[160:161] op_sel:[1,0,0] op_sel_hi:[1,1,1] neg_lo:[1,0,0] neg_hi:[1,0,0]
v_pk_fma_f32 v[162:163], v[128:129], v[164:165], v[162:163] op_sel:[1,0,0] op_sel_hi:[1,1,1]
v_pk_fma_f32 v[164:165], v[128:129], v[160:161], v[80:81] op_sel:[0,0,0] op_sel_hi:[0,1,1]
v_pk_fma_f32 v[166:167], v[128:129], v[162:163], v[112:113] op_sel:[0,0,0] op_sel_hi:[0,1,1]
v_pk_fma_f32 v[164:165], v[128:129], v[162:163], v[164:165] op_sel:[1,0,0] op_sel_hi:[1,1,1] neg_lo:[1,0,0] neg_hi:[1,0,0]
v_pk_fma_f32 v[166:167], v[128:129], v[160:161], v[166:167] op_sel:[1,0,0] op_sel_hi:[1,1,1]
v_pk_fma_f32 v[160:161], v[128:129], v[164:165], v[82:83] op_sel:[0,0,0] op_sel_hi:[0,1,1]
v_pk_fma_f32 v[162:163], v[128:129], v[166:167], v[114:115] op_sel:[0,0,0] op_sel_hi:[0,1,1]
v_pk_fma_f32 v[160:161], v[128:129], v[166:167], v[160:161] op_sel:[1,0,0] op_sel_hi:[1,1,1] neg_lo:[1,0,0] neg_hi:[1,0,0]
v_pk_fma_f32 v[162:163], v[128:129], v[164:165], v[162:163] op_sel:[1,0,0] op_sel_hi:[1,1,1]
v_pk_fma_f32 v[164:165], v[128:129], v[160:161], v[84:85] op_sel:[0,0,0] op_sel_hi:[0,1,1]
v_pk_fma_f32 v[166:167], v[128:129], v[162:163], v[116:117] op_sel:[0,0,0] op_sel_hi:[0,1,1]
v_pk_fma_f32 v[164:165], v[128:129], v[162:163], v[164:165] op_sel:[1,0,0] op_sel_hi:[1,1,1] neg_lo:[1,0,0] neg_hi:[1,0,0]
v_pk_fma_f32 v[166:167], v[128:129], v[160:161], v[166:167] op_sel:[1,0,0] op_sel_hi:[1,1,1]
v_pk_fma_f32 v[160:161], v[128:129], v[164:165], v[86:87] op_sel:[0,0,0] op_sel_hi:[0,1,1]
v_pk_fma_f32 v[162:163], v[128:129], v[166:167], v[118:119] op_sel:[0,0,0] op_sel_hi:[0,1,1]
v_pk_fma_f32 v[160:161], v[128:129], v[166:167], v[160:161] op_sel:[1,0,0] op_sel_hi:[1,1,1] neg_lo:[1,0,0] neg_hi:[1,0,0]
v_pk_fma_f32 v[162:163], v[128:129], v[164:165], v[162:163] op_sel:[1,0,0] op_sel_hi:[1,1,1]
v_pk_fma_f32 v[164:165], v[128:129], v[160:161], v[88:89] op_sel:[0,0,0] op_sel_hi:[0,1,1]
v_pk_fma_f32 v[166:167], v[128:129], v[162:163], v[120:121] op_sel:[0,0,0] op_sel_hi:[0,1,1]
v_pk_fma_f32 v[164:165], v[128:129], v[162:163], v[164:165] op_sel:[1,0,0] op_sel_hi:[1,1,1] neg_lo:[1,0,0] neg_hi:[1,0,0]
v_pk_fma_f32 v[166:167], v[128:129], v[160:161], v[166:167] op_sel:[1,0,0] op_sel_hi:[1,1,1]
v_pk_fma_f32 v[160:161], v[128:129], v[164:165], v[90:91] op_sel:[0,0,0] op_sel_hi:[0,1,1]
v_pk_fma_f32 v[162:163], v[128:129], v[166:167], v[122:123] op_sel:[0,0,0] op_sel_hi:[0,1,1]
v_pk_fma_f32 v[160:161], v[128:129], v[166:167], v[160:161] op_sel:[1,0,0] op_sel_hi:[1,1,1] neg_lo:[1,0,0] neg_hi:[1,0,0]
v_pk_fma_f32 v[162:163], v[128:129], v[164:165], v[162:163] op_sel:[1,0,0] op_sel_hi:[1,1,1]
v_pk_fma_f32 v[164:165], v[128:129], v[160:161], v[92:93] op_sel:[0,0,0] op_sel_hi:[0,1,1]
v_pk_fma_f32 v[166:167], v[128:129], v[162:163], v[124:125] op_sel:[0,0,0] op_sel_hi:[0,1,1]
v_pk_fma_f32 v[164:165], v[128:129], v[162:163], v[164:165] op_sel:[1,0,0] op_sel_hi:[1,1,1] neg_lo:[1,0,0] neg_hi:[1,0,0]
v_pk_fma_f32 v[166:167], v[128:129], v[160:161], v[166:167] op_sel:[1,0,0] op_sel_hi:[1,1,1]
v_pk_fma_f32 v[160:161], v[128:129], v[164:165], v[94:95] op_sel:[0,0,0] op_sel_hi:[0,1,1]
v_pk_fma_f32 v[162:163], v[128:129], v[166:167], v[126:127] op_sel:[0,0,0] op_sel_hi:[0,1,1]
v_pk_fma_f32 v[160:161], v[128:129], v[166:167], v[160:161] op_sel:[1,0,0] op_sel_hi:[1,1,1] neg_lo:[1,0,0] neg_hi:[1,0,0]
v_pk_fma_f32 v[162:163], v[128:129], v[164:165], v[162:163] op_sel:[1,0,0] op_sel_hi:[1,1,1]
v_mov_b32 v168, v160
v_mov_b32 v169, v162
v_mov_b32 v170, v161
v_mov_b32 v171, v163
ds_write_b64 v159, v[168:169]
ds_write_b64 v159, v[170:171] offset:512
s_waitcnt lgkmcnt(0)
s_barrier
ds_read_b64 v[172:173], v158 offset:0
ds_read_b64 v[174:175], v158 offset:512
ds_read_b64 v[176:177], v158 offset:1024
ds_read_b64 v[178:179], v158 offset:1536
ds_read_b64 v[180:181], v158 offset:2048
ds_read_b64 v[182:183], v158 offset:2560
ds_read_b64 v[184:185], v158 offset:3072
ds_read_b64 v[186:187], v158 offset:3584
s_waitcnt lgkmcnt(0)
v_fma_f32 v174, v132, v172, v174
v_fma_f32 v175, v132, v173, v175
v_fma_f32 v174, -v133, v173, v174
v_fma_f32 v175, v133, v172, v175
v_fma_f32 v176, v132, v174, v176
v_fma_f32 v177, v132, v175, v177
v_fma_f32 v176, -v133, v175, v176
v_fma_f32 v177, v133, v174, v177
v_fma_f32 v178, v132, v176, v178
v_fma_f32 v179, v132, v177, v179
v_fma_f32 v178, -v133, v177, v178
v_fma_f32 v179, v133, v176, v179
v_fma_f32 v180, v132, v178, v180
v_fma_f32 v181, v132, v179, v181
v_fma_f32 v180, -v133, v179, v180
v_fma_f32 v181, v133, v178, v181
v_fma_f32 v182, v132, v180, v182
v_fma_f32 v183, v132, v181, v183
v_fma_f32 v182, -v133, v181, v182
v_fma_f32 v183, v133, v180, v183
v_fma_f32 v184, v132, v182, v184
v_fma_f32 v185, v132, v183, v185
v_fma_f32 v184, -v133, v183, v184
v_fma_f32 v185, v133, v182, v185
v_fma_f32 v186, v132, v184, v186
v_fma_f32 v187, v132, v185, v187
v_fma_f32 v186, -v133, v185, v186
v_fma_f32 v187, v133, v184, v187
s_lshr_b32 s7, s6, 1
s_cmp_eq_u32 s7, 0
s_cbranch_scc0 LA_th1
v_or_b32 v160, 1, v186
v_or_b32 v161, 1, v187
s_mov_b64 exec, s[50:51]
buffer_store_dwordx2 v[160:161], v155, s[20:23], 0 offen sc1
s_mov_b64 exec, -1
v_cndmask_b32 v168, v174, 0, s[50:51]
v_cndmask_b32 v169, v175, 0, s[50:51]
v_cndmask_b32 v170, v176, v172, s[50:51]
v_cndmask_b32 v171, v177, v173, s[50:51]
s_barrier
ds_read_b64 v[164:165], v158 offset:4096
s_waitcnt lgkmcnt(0)
s_branch LA_thj
LA_th1:
buffer_load_dwordx2 v[188:189], v150, s[20:23], 0 offen sc1
v_subrev_u32 v8, 7168, v150
buffer_load_dwordx2 v[190:191], v8, s[20:23], 0 offen sc1
v_subrev_u32 v8, 14336, v150
buffer_load_dwordx2 v[192:193], v8, s[20:23], 0 offen sc1
v_subrev_u32 v8, 21504, v150
buffer_load_dwordx2 v[194:195], v8, s[20:23], 0 offen sc1
v_subrev_u32 v8, 28672, v150
buffer_load_dwordx2 v[196:197], v8, s[20:23], 0 offen sc1
v_subrev_u32 v8, 35840, v150
buffer_load_dwordx2 v[198:199], v8, s[20:23], 0 offen sc1
v_subrev_u32 v8, 43008, v150
buffer_load_dwordx2 v[200:201], v8, s[20:23], 0 offen sc1
v_subrev_u32 v8, 50176, v150
buffer_load_dwordx2 v[202:203], v8, s[20:23], 0 offen sc1
v_cndmask_b32 v168, v182, v178, s[50:51]
v_cndmask_b32 v169, v183, v179, s[50:51]
v_cndmask_b32 v170, v184, v180, s[50:51]
v_cndmask_b32 v171, v185, v181, s[50:51]
s_mov_b32 s46, 0
s_branch LA_pe_w
LA_pe:
buffer_load_dwordx2 v[188:189], v150, s[20:23], 0 offen sc1
v_subrev_u32 v8, 7168, v150
buffer_load_dwordx2 v[190:191], v8, s[20:23], 0 offen sc1
v_subrev_u32 v8, 14336, v150
buffer_load_dwordx2 v[192:193], v8, s[20:23], 0 offen sc1
v_subrev_u32 v8, 21504, v150
buffer_load_dwordx2 v[194:195], v8, s[20:23], 0 offen sc1
v_subrev_u32 v8, 28672, v150
buffer_load_dwordx2 v[196:197], v8, s[20:23], 0 offen sc1
v_subrev_u32 v8, 35840, v150
buffer_load_dwordx2 v[198:199], v8, s[20:23], 0 offen sc1
v_subrev_u32 v8, 43008, v150
buffer_load_dwordx2 v[200:201], v8, s[20:23], 0 offen sc1
v_subrev_u32 v8, 50176, v150
buffer_load_dwordx2 v[202:203], v8, s[20:23], 0 offen sc1
LA_pe_w:
s_waitcnt vmcnt(0)
v_and_b32 v8, v188, v189
v_and_b32 v8, 1, v8
v_and_b32 v9, v190, v191
v_and_b32 v9, 1, v9
v_add_u32 v8, v8, v9
v_and_b32 v9, v192, v193
v_and_b32 v9, 1, v9
v_add_u32 v8, v8, v9
v_and_b32 v9, v194, v195
v_and_b32 v9, 1, v9
v_add_u32 v8, v8, v9
v_and_b32 v9, v196, v197
v_and_b32 v9, 1, v9
v_add_u32 v8, v8, v9
v_and_b32 v9, v198, v199
v_and_b32 v9, 1, v9
v_add_u32 v8, v8, v9
v_and_b32 v9, v200, v201
v_and_b32 v9, 1, v9
v_add_u32 v8, v8, v9
v_and_b32 v9, v202, v203
v_and_b32 v9, 1, v9
v_add_u32 v8, v8, v9
v_cmp_eq_u32 vcc, v8, v151
s_cmp_eq_u64 vcc, exec
s_cbranch_scc1 LA_pe_ok
s_add_u32 s46, s46, 1
s_cmp_lt_u32 s46, 0x40000
s_cbranch_scc1 LA_pe
LA_pe_ok:
v_fma_f32 v200, v140, v202, v200
v_fma_f32 v201, v140, v203, v201
v_fma_f32 v200, -v141, v203, v200
v_fma_f32 v201, v141, v202, v201
v_fma_f32 v198, v140, v200, v198
v_fma_f32 v199, v140, v201, v199
v_fma_f32 v198, -v141, v201, v198
v_fma_f32 v199, v141, v200, v199
v_fma_f32 v196, v140, v198, v196
v_fma_f32 v197, v140, v199, v197
v_fma_f32 v196, -v141, v199, v196
v_fma_f32 v197, v141, v198, v197
v_fma_f32 v194, v140, v196, v194
v_fma_f32 v195, v140, v197, v195
v_fma_f32 v194, -v141, v197, v194
v_fma_f32 v195, v141, v196, v195
v_fma_f32 v192, v140, v194, v192
v_fma_f32 v193, v140, v195, v193
v_fma_f32 v192, -v141, v195, v192
v_fma_f32 v193, v141, v194, v193
v_fma_f32 v190, v140, v192, v190
v_fma_f32 v191, v140, v193, v191
v_fma_f32 v190, -v141, v193, v190
v_fma_f32 v191, v141, v192, v191
v_fma_f32 v188, v140, v190, v188
v_fma_f32 v189, v140, v191, v189
v_fma_f32 v188, -v141, v191, v188
v_fma_f32 v189, v141, v190, v189
v_mov_b32 v160, v188
v_mov_b32 v161, v189
v_mov_b32 v162, v188
v_mov_b32 v163, v189
s_nop 0
v_permlane32_swap_b32 v160, v162
v_permlane32_swap_b32 v161, v163
v_fma_f32 v164, v134, v162, v160
v_fma_f32 v165, v134, v163, v161
v_fma_f32 v164, -v135, v163, v164
v_fma_f32 v165, v135, v162, v165
ds_write_b64 v158, v[164:165] offset:4096
s_waitcnt lgkmcnt(0)
s_barrier
LA_thj:
v_fma_f32 v168, v136, v164, v168
v_fma_f32 v169, v136, v165, v169
v_fma_f32 v168, -v137, v165, v168
v_fma_f32 v169, v137, v164, v169
v_fma_f32 v170, v138, v164, v170
v_fma_f32 v171, v138, v165, v171
v_fma_f32 v170, -v139, v165, v170
v_fma_f32 v171, v139, v164, v171
v_mov_b32 v160, v168
v_mov_b32 v161, v170
v_mov_b32 v162, v169
v_mov_b32 v163, v171
v_pk_fma_f32 v[64:65], v[128:129], v[160:161], v[64:65] op_sel:[0,0,0] op_sel_hi:[0,1,1]
v_pk_fma_f32 v[96:97], v[128:129], v[162:163], v[96:97] op_sel:[0,0,0] op_sel_hi:[0,1,1]
v_pk_fma_f32 v[64:65], v[128:129], v[162:163], v[64:65] op_sel:[1,0,0] op_sel_hi:[1,1,1] neg_lo:[1,0,0] neg_hi:[1,0,0]
v_pk_fma_f32 v[96:97], v[128:129], v[160:161], v[96:97] op_sel:[1,0,0] op_sel_hi:[1,1,1]
v_pk_mul_f32 v[164:165], v[130:131], v[64:65] op_sel:[0,0] op_sel_hi:[0,1]
v_pk_mul_f32 v[166:167], v[130:131], v[96:97] op_sel:[0,0] op_sel_hi:[0,1] neg_lo:[1,0] neg_hi:[1,0]
v_pk_fma_f32 v[164:165], v[130:131], v[96:97], v[164:165] op_sel:[1,0,0] op_sel_hi:[1,1,1] neg_lo:[1,0,0] neg_hi:[1,0,0]
v_pk_fma_f32 v[166:167], v[130:131], v[64:65], v[166:167] op_sel:[1,0,0] op_sel_hi:[1,1,1] neg_lo:[1,0,0] neg_hi:[1,0,0]
v_cvt_pk_bf16_f32 v172, v164, v165
v_cvt_pk_bf16_f32 v188, v166, v167
v_pk_fma_f32 v[66:67], v[128:129], v[64:65], v[66:67] op_sel:[0,0,0] op_sel_hi:[0,1,1]
v_pk_fma_f32 v[98:99], v[128:129], v[96:97], v[98:99] op_sel:[0,0,0] op_sel_hi:[0,1,1]
v_pk_fma_f32 v[66:67], v[128:129], v[96:97], v[66:67] op_sel:[1,0,0] op_sel_hi:[1,1,1] neg_lo:[1,0,0] neg_hi:[1,0,0]
v_pk_fma_f32 v[98:99], v[128:129], v[64:65], v[98:99] op_sel:[1,0,0] op_sel_hi:[1,1,1]
v_pk_mul_f32 v[164:165], v[130:131], v[66:67] op_sel:[0,0] op_sel_hi:[0,1]
v_pk_mul_f32 v[166:167], v[130:131], v[98:99] op_sel:[0,0] op_sel_hi:[0,1] neg_lo:[1,0] neg_hi:[1,0]
v_pk_fma_f32 v[164:165], v[130:131], v[98:99], v[164:165] op_sel:[1,0,0] op_sel_hi:[1,1,1] neg_lo:[1,0,0] neg_hi:[1,0,0]
v_pk_fma_f32 v[166:167], v[130:131], v[66:67], v[166:167] op_sel:[1,0,0] op_sel_hi:[1,1,1] neg_lo:[1,0,0] neg_hi:[1,0,0]
v_cvt_pk_bf16_f32 v173, v164, v165
v_cvt_pk_bf16_f32 v189, v166, v167
v_pk_fma_f32 v[68:69], v[128:129], v[66:67], v[68:69] op_sel:[0,0,0] op_sel_hi:[0,1,1]
v_pk_fma_f32 v[100:101], v[128:129], v[98:99], v[100:101] op_sel:[0,0,0] op_sel_hi:[0,1,1]
v_pk_fma_f32 v[68:69], v[128:129], v[98:99], v[68:69] op_sel:[1,0,0] op_sel_hi:[1,1,1] neg_lo:[1,0,0] neg_hi:[1,0,0]
v_pk_fma_f32 v[100:101], v[128:129], v[66:67], v[100:101] op_sel:[1,0,0] op_sel_hi:[1,1,1]
v_pk_mul_f32 v[164:165], v[130:131], v[68:69] op_sel:[0,0] op_sel_hi:[0,1]
v_pk_mul_f32 v[166:167], v[130:131], v[100:101] op_sel:[0,0] op_sel_hi:[0,1] neg_lo:[1,0] neg_hi:[1,0]
v_pk_fma_f32 v[164:165], v[130:131], v[100:101], v[164:165] op_sel:[1,0,0] op_sel_hi:[1,1,1] neg_lo:[1,0,0] neg_hi:[1,0,0]
v_pk_fma_f32 v[166:167], v[130:131], v[68:69], v[166:167] op_sel:[1,0,0] op_sel_hi:[1,1,1] neg_lo:[1,0,0] neg_hi:[1,0,0]
v_cvt_pk_bf16_f32 v174, v164, v165
v_cvt_pk_bf16_f32 v190, v166, v167
v_pk_fma_f32 v[70:71], v[128:129], v[68:69], v[70:71] op_sel:[0,0,0] op_sel_hi:[0,1,1]
v_pk_fma_f32 v[102:103], v[128:129], v[100:101], v[102:103] op_sel:[0,0,0] op_sel_hi:[0,1,1]
v_pk_fma_f32 v[70:71], v[128:129], v[100:101], v[70:71] op_sel:[1,0,0] op_sel_hi:[1,1,1] neg_lo:[1,0,0] neg_hi:[1,0,0]
v_pk_fma_f32 v[102:103], v[128:129], v[68:69], v[102:103] op_sel:[1,0,0] op_sel_hi:[1,1,1]
v_pk_mul_f32 v[164:165], v[130:131], v[70:71] op_sel:[0,0] op_sel_hi:[0,1]
v_pk_mul_f32 v[166:167], v[130:131], v[102:103] op_sel:[0,0] op_sel_hi:[0,1] neg_lo:[1,0] neg_hi:[1,0]
v_pk_fma_f32 v[164:165], v[130:131], v[102:103], v[164:165] op_sel:[1,0,0] op_sel_hi:[1,1,1] neg_lo:[1,0,0] neg_hi:[1,0,0]
v_pk_fma_f32 v[166:167], v[130:131], v[70:71], v[166:167] op_sel:[1,0,0] op_sel_hi:[1,1,1] neg_lo:[1,0,0] neg_hi:[1,0,0]
v_cvt_pk_bf16_f32 v175, v164, v165
v_cvt_pk_bf16_f32 v191, v166, v167
ds_write_b128 v152, v[172:175] offset:0
ds_write_b128 v152, v[188:191] offset:4608
v_pk_fma_f32 v[72:73], v[128:129], v[70:71], v[72:73] op_sel:[0,0,0] op_sel_hi:[0,1,1]
v_pk_fma_f32 v[104:105], v[128:129], v[102:103], v[104:105] op_sel:[0,0,0] op_sel_hi:[0,1,1]
v_pk_fma_f32 v[72:73], v[128:129], v[102:103], v[72:73] op_sel:[1,0,0] op_sel_hi:[1,1,1] neg_lo:[1,0,0] neg_hi:[1,0,0]
v_pk_fma_f32 v[104:105], v[128:129], v[70:71], v[104:105] op_sel:[1,0,0] op_sel_hi:[1,1,1]
v_pk_mul_f32 v[164:165], v[130:131], v[72:73] op_sel:[0,0] op_sel_hi:[0,1]
v_pk_mul_f32 v[166:167], v[130:131], v[104:105] op_sel:[0,0] op_sel_hi:[0,1] neg_lo:[1,0] neg_hi:[1,0]
v_pk_fma_f32 v[164:165], v[130:131], v[104:105], v[164:165] op_sel:[1,0,0] op_sel_hi:[1,1,1] neg_lo:[1,0,0] neg_hi:[1,0,0]
v_pk_fma_f32 v[166:167], v[130:131], v[72:73], v[166:167] op_sel:[1,0,0] op_sel_hi:[1,1,1] neg_lo:[1,0,0] neg_hi:[1,0,0]
v_cvt_pk_bf16_f32 v176, v164, v165
v_cvt_pk_bf16_f32 v192, v166, v167
v_pk_fma_f32 v[74:75], v[128:129], v[72:73], v[74:75] op_sel:[0,0,0] op_sel_hi:[0,1,1]
v_pk_fma_f32 v[106:107], v[128:129], v[104:105], v[106:107] op_sel:[0,0,0] op_sel_hi:[0,1,1]
v_pk_fma_f32 v[74:75], v[128:129], v[104:105], v[74:75] op_sel:[1,0,0] op_sel_hi:[1,1,1] neg_lo:[1,0,0] neg_hi:[1,0,0]
v_pk_fma_f32 v[106:107], v[128:129], v[72:73], v[106:107] op_sel:[1,0,0] op_sel_hi:[1,1,1]
v_pk_mul_f32 v[164:165], v[130:131], v[74:75] op_sel:[0,0] op_sel_hi:[0,1]
v_pk_mul_f32 v[166:167], v[130:131], v[106:107] op_sel:[0,0] op_sel_hi:[0,1] neg_lo:[1,0] neg_hi:[1,0]
v_pk_fma_f32 v[164:165], v[130:131], v[106:107], v[164:165] op_sel:[1,0,0] op_sel_hi:[1,1,1] neg_lo:[1,0,0] neg_hi:[1,0,0]
v_pk_fma_f32 v[166:167], v[130:131], v[74:75], v[166:167] op_sel:[1,0,0] op_sel_hi:[1,1,1] neg_lo:[1,0,0] neg_hi:[1,0,0]
v_cvt_pk_bf16_f32 v177, v164, v165
v_cvt_pk_bf16_f32 v193, v166, v167
v_pk_fma_f32 v[76:77], v[128:129], v[74:75], v[76:77] op_sel:[0,0,0] op_sel_hi:[0,1,1]
v_pk_fma_f32 v[108:109], v[128:129], v[106:107], v[108:109] op_sel:[0,0,0] op_sel_hi:[0,1,1]
v_pk_fma_f32 v[76:77], v[128:129], v[106:107], v[76:77] op_sel:[1,0,0] op_sel_hi:[1,1,1] neg_lo:[1,0,0] neg_hi:[1,0,0]
v_pk_fma_f32 v[108:109], v[128:129], v[74:75], v[108:109] op_sel:[1,0,0] op_sel_hi:[1,1,1]
v_pk_mul_f32 v[164:165], v[130:131], v[76:77] op_sel:[0,0] op_sel_hi:[0,1]
v_pk_mul_f32 v[166:167], v[130:131], v[108:109] op_sel:[0,0] op_sel_hi:[0,1] neg_lo:[1,0] neg_hi:[1,0]
v_pk_fma_f32 v[164:165], v[130:131], v[108:109], v[164:165] op_sel:[1,0,0] op_sel_hi:[1,1,1] neg_lo:[1,0,0] neg_hi:[1,0,0]
v_pk_fma_f32 v[166:167], v[130:131], v[76:77], v[166:167] op_sel:[1,0,0] op_sel_hi:[1,1,1] neg_lo:[1,0,0] neg_hi:[1,0,0]
v_cvt_pk_bf16_f32 v178, v164, v165
v_cvt_pk_bf16_f32 v194, v166, v167
v_pk_fma_f32 v[78:79], v[128:129], v[76:77], v[78:79] op_sel:[0,0,0] op_sel_hi:[0,1,1]
v_pk_fma_f32 v[110:111], v[128:129], v[108:109], v[110:111] op_sel:[0,0,0] op_sel_hi:[0,1,1]
v_pk_fma_f32 v[78:79], v[128:129], v[108:109], v[78:79] op_sel:[1,0,0] op_sel_hi:[1,1,1] neg_lo:[1,0,0] neg_hi:[1,0,0]
v_pk_fma_f32 v[110:111], v[128:129], v[76:77], v[110:111] op_sel:[1,0,0] op_sel_hi:[1,1,1]
v_pk_mul_f32 v[164:165], v[130:131], v[78:79] op_sel:[0,0] op_sel_hi:[0,1]
v_pk_mul_f32 v[166:167], v[130:131], v[110:111] op_sel:[0,0] op_sel_hi:[0,1] neg_lo:[1,0] neg_hi:[1,0]
v_pk_fma_f32 v[164:165], v[130:131], v[110:111], v[164:165] op_sel:[1,0,0] op_sel_hi:[1,1,1] neg_lo:[1,0,0] neg_hi:[1,0,0]
v_pk_fma_f32 v[166:167], v[130:131], v[78:79], v[166:167] op_sel:[1,0,0] op_sel_hi:[1,1,1] neg_lo:[1,0,0] neg_hi:[1,0,0]
v_cvt_pk_bf16_f32 v179, v164, v165
v_cvt_pk_bf16_f32 v195, v166, v167
ds_write_b128 v152, v[176:179] offset:16
ds_write_b128 v152, v[192:195] offset:4624
v_pk_fma_f32 v[80:81], v[128:129], v[78:79], v[80:81] op_sel:[0,0,0] op_sel_hi:[0,1,1]
v_pk_fma_f32 v[112:113], v[128:129], v[110:111], v[112:113] op_sel:[0,0,0] op_sel_hi:[0,1,1]
v_pk_fma_f32 v[80:81], v[128:129], v[110:111], v[80:81] op_sel:[1,0,0] op_sel_hi:[1,1,1] neg_lo:[1,0,0] neg_hi:[1,0,0]
v_pk_fma_f32 v[112:113], v[128:129], v[78:79], v[112:113] op_sel:[1,0,0] op_sel_hi:[1,1,1]
v_pk_mul_f32 v[164:165], v[130:131], v[80:81] op_sel:[0,0] op_sel_hi:[0,1]
v_pk_mul_f32 v[166:167], v[130:131], v[112:113] op_sel:[0,0] op_sel_hi:[0,1] neg_lo:[1,0] neg_hi:[1,0]
v_pk_fma_f32 v[164:165], v[130:131], v[112:113], v[164:165] op_sel:[1,0,0] op_sel_hi:[1,1,1] neg_lo:[1,0,0] neg_hi:[1,0,0]
v_pk_fma_f32 v[166:167], v[130:131], v[80:81], v[166:167] op_sel:[1,0,0] op_sel_hi:[1,1,1] neg_lo:[1,0,0] neg_hi:[1,0,0]
v_cvt_pk_bf16_f32 v180, v164, v165
v_cvt_pk_bf16_f32 v196, v166, v167
v_pk_fma_f32 v[82:83], v[128:129], v[80:81], v[82:83] op_sel:[0,0,0] op_sel_hi:[0,1,1]
v_pk_fma_f32 v[114:115], v[128:129], v[112:113], v[114:115] op_sel:[0,0,0] op_sel_hi:[0,1,1]
v_pk_fma_f32 v[82:83], v[128:129], v[112:113], v[82:83] op_sel:[1,0,0] op_sel_hi:[1,1,1] neg_lo:[1,0,0] neg_hi:[1,0,0]
v_pk_fma_f32 v[114:115], v[128:129], v[80:81], v[114:115] op_sel:[1,0,0] op_sel_hi:[1,1,1]
v_pk_mul_f32 v[164:165], v[130:131], v[82:83] op_sel:[0,0] op_sel_hi:[0,1]
v_pk_mul_f32 v[166:167], v[130:131], v[114:115] op_sel:[0,0] op_sel_hi:[0,1] neg_lo:[1,0] neg_hi:[1,0]
v_pk_fma_f32 v[164:165], v[130:131], v[114:115], v[164:165] op_sel:[1,0,0] op_sel_hi:[1,1,1] neg_lo:[1,0,0] neg_hi:[1,0,0]
v_pk_fma_f32 v[166:167], v[130:131], v[82:83], v[166:167] op_sel:[1,0,0] op_sel_hi:[1,1,1] neg_lo:[1,0,0] neg_hi:[1,0,0]
v_cvt_pk_bf16_f32 v181, v164, v165
v_cvt_pk_bf16_f32 v197, v166, v167
v_pk_fma_f32 v[84:85], v[128:129], v[82:83], v[84:85] op_sel:[0,0,0] op_sel_hi:[0,1,1]
v_pk_fma_f32 v[116:117], v[128:129], v[114:115], v[116:117] op_sel:[0,0,0] op_sel_hi:[0,1,1]
v_pk_fma_f32 v[84:85], v[128:129], v[114:115], v[84:85] op_sel:[1,0,0] op_sel_hi:[1,1,1] neg_lo:[1,0,0] neg_hi:[1,0,0]
v_pk_fma_f32 v[116:117], v[128:129], v[82:83], v[116:117] op_sel:[1,0,0] op_sel_hi:[1,1,1]
v_pk_mul_f32 v[164:165], v[130:131], v[84:85] op_sel:[0,0] op_sel_hi:[0,1]
v_pk_mul_f32 v[166:167], v[130:131], v[116:117] op_sel:[0,0] op_sel_hi:[0,1] neg_lo:[1,0] neg_hi:[1,0]
v_pk_fma_f32 v[164:165], v[130:131], v[116:117], v[164:165] op_sel:[1,0,0] op_sel_hi:[1,1,1] neg_lo:[1,0,0] neg_hi:[1,0,0]
v_pk_fma_f32 v[166:167], v[130:131], v[84:85], v[166:167] op_sel:[1,0,0] op_sel_hi:[1,1,1] neg_lo:[1,0,0] neg_hi:[1,0,0]
v_cvt_pk_bf16_f32 v182, v164, v165
v_cvt_pk_bf16_f32 v198, v166, v167
v_pk_fma_f32 v[86:87], v[128:129], v[84:85], v[86:87] op_sel:[0,0,0] op_sel_hi:[0,1,1]
v_pk_fma_f32 v[118:119], v[128:129], v[116:117], v[118:119] op_sel:[0,0,0] op_sel_hi:[0,1,1]
v_pk_fma_f32 v[86:87], v[128:129], v[116:117], v[86:87] op_sel:[1,0,0] op_sel_hi:[1,1,1] neg_lo:[1,0,0] neg_hi:[1,0,0]
v_pk_fma_f32 v[118:119], v[128:129], v[84:85], v[118:119] op_sel:[1,0,0] op_sel_hi:[1,1,1]
v_pk_mul_f32 v[164:165], v[130:131], v[86:87] op_sel:[0,0] op_sel_hi:[0,1]
v_pk_mul_f32 v[166:167], v[130:131], v[118:119] op_sel:[0,0] op_sel_hi:[0,1] neg_lo:[1,0] neg_hi:[1,0]
v_pk_fma_f32 v[164:165], v[130:131], v[118:119], v[164:165] op_sel:[1,0,0] op_sel_hi:[1,1,1] neg_lo:[1,0,0] neg_hi:[1,0,0]
v_pk_fma_f32 v[166:167], v[130:131], v[86:87], v[166:167] op_sel:[1,0,0] op_sel_hi:[1,1,1] neg_lo:[1,0,0] neg_hi:[1,0,0]
v_cvt_pk_bf16_f32 v183, v164, v165
v_cvt_pk_bf16_f32 v199, v166, v167
ds_write_b128 v152, v[180:183] offset:32
ds_write_b128 v152, v[196:199] offset:4640
v_pk_fma_f32 v[88:89], v[128:129], v[86:87], v[88:89] op_sel:[0,0,0] op_sel_hi:[0,1,1]
v_pk_fma_f32 v[120:121], v[128:129], v[118:119], v[120:121] op_sel:[0,0,0] op_sel_hi:[0,1,1]
v_pk_fma_f32 v[88:89], v[128:129], v[118:119], v[88:89] op_sel:[1,0,0] op_sel_hi:[1,1,1] neg_lo:[1,0,0] neg_hi:[1,0,0]
v_pk_fma_f32 v[120:121], v[128:129], v[86:87], v[120:121] op_sel:[1,0,0] op_sel_hi:[1,1,1]
v_pk_mul_f32 v[164:165], v[130:131], v[88:89] op_sel:[0,0] op_sel_hi:[0,1]
v_pk_mul_f32 v[166:167], v[130:131], v[120:121] op_sel:[0,0] op_sel_hi:[0,1] neg_lo:[1,0] neg_hi:[1,0]
v_pk_fma_f32 v[164:165], v[130:131], v[120:121], v[164:165] op_sel:[1,0,0] op_sel_hi:[1,1,1] neg_lo:[1,0,0] neg_hi:[1,0,0]
v_pk_fma_f32 v[166:167], v[130:131], v[88:89], v[166:167] op_sel:[1,0,0] op_sel_hi:[1,1,1] neg_lo:[1,0,0] neg_hi:[1,0,0]
v_cvt_pk_bf16_f32 v184, v164, v165
v_cvt_pk_bf16_f32 v200, v166, v167
v_pk_fma_f32 v[90:91], v[128:129], v[88:89], v[90:91] op_sel:[0,0,0] op_sel_hi:[0,1,1]
v_pk_fma_f32 v[122:123], v[128:129], v[120:121], v[122:123] op_sel:[0,0,0] op_sel_hi:[0,1,1]
v_pk_fma_f32 v[90:91], v[128:129], v[120:121], v[90:91] op_sel:[1,0,0] op_sel_hi:[1,1,1] neg_lo:[1,0,0] neg_hi:[1,0,0]
v_pk_fma_f32 v[122:123], v[128:129], v[88:89], v[122:123] op_sel:[1,0,0] op_sel_hi:[1,1,1]
v_pk_mul_f32 v[164:165], v[130:131], v[90:91] op_sel:[0,0] op_sel_hi:[0,1]
v_pk_mul_f32 v[166:167], v[130:131], v[122:123] op_sel:[0,0] op_sel_hi:[0,1] neg_lo:[1,0] neg_hi:[1,0]
v_pk_fma_f32 v[164:165], v[130:131], v[122:123], v[164:165] op_sel:[1,0,0] op_sel_hi:[1,1,1] neg_lo:[1,0,0] neg_hi:[1,0,0]
v_pk_fma_f32 v[166:167], v[130:131], v[90:91], v[166:167] op_sel:[1,0,0] op_sel_hi:[1,1,1] neg_lo:[1,0,0] neg_hi:[1,0,0]
v_cvt_pk_bf16_f32 v185, v164, v165
v_cvt_pk_bf16_f32 v201, v166, v167
v_pk_fma_f32 v[92:93], v[128:129], v[90:91], v[92:93] op_sel:[0,0,0] op_sel_hi:[0,1,1]
v_pk_fma_f32 v[124:125], v[128:129], v[122:123], v[124:125] op_sel:[0,0,0] op_sel_hi:[0,1,1]
v_pk_fma_f32 v[92:93], v[128:129], v[122:123], v[92:93] op_sel:[1,0,0] op_sel_hi:[1,1,1] neg_lo:[1,0,0] neg_hi:[1,0,0]
v_pk_fma_f32 v[124:125], v[128:129], v[90:91], v[124:125] op_sel:[1,0,0] op_sel_hi:[1,1,1]
v_pk_mul_f32 v[164:165], v[130:131], v[92:93] op_sel:[0,0] op_sel_hi:[0,1]
v_pk_mul_f32 v[166:167], v[130:131], v[124:125] op_sel:[0,0] op_sel_hi:[0,1] neg_lo:[1,0] neg_hi:[1,0]
v_pk_fma_f32 v[164:165], v[130:131], v[124:125], v[164:165] op_sel:[1,0,0] op_sel_hi:[1,1,1] neg_lo:[1,0,0] neg_hi:[1,0,0]
v_pk_fma_f32 v[166:167], v[130:131], v[92:93], v[166:167] op_sel:[1,0,0] op_sel_hi:[1,1,1] neg_lo:[1,0,0] neg_hi:[1,0,0]
v_cvt_pk_bf16_f32 v186, v164, v165
v_cvt_pk_bf16_f32 v202, v166, v167
v_pk_fma_f32 v[94:95], v[128:129], v[92:93], v[94:95] op_sel:[0,0,0] op_sel_hi:[0,1,1]
v_pk_fma_f32 v[126:127], v[128:129], v[124:125], v[126:127] op_sel:[0,0,0] op_sel_hi:[0,1,1]
v_pk_fma_f32 v[94:95], v[128:129], v[124:125], v[94:95] op_sel:[1,0,0] op_sel_hi:[1,1,1] neg_lo:[1,0,0] neg_hi:[1,0,0]
v_pk_fma_f32 v[126:127], v[128:129], v[92:93], v[126:127] op_sel:[1,0,0] op_sel_hi:[1,1,1]
v_pk_mul_f32 v[164:165], v[130:131], v[94:95] op_sel:[0,0] op_sel_hi:[0,1]
v_pk_mul_f32 v[166:167], v[130:131], v[126:127] op_sel:[0,0] op_sel_hi:[0,1] neg_lo:[1,0] neg_hi:[1,0]
v_pk_fma_f32 v[164:165], v[130:131], v[126:127], v[164:165] op_sel:[1,0,0] op_sel_hi:[1,1,1] neg_lo:[1,0,0] neg_hi:[1,0,0]
v_pk_fma_f32 v[166:167], v[130:131], v[94:95], v[166:167] op_sel:[1,0,0] op_sel_hi:[1,1,1] neg_lo:[1,0,0] neg_hi:[1,0,0]
v_cvt_pk_bf16_f32 v187, v164, v165
v_cvt_pk_bf16_f32 v203, v166, v167
ds_write_b128 v152, v[184:187] offset:48
ds_write_b128 v152, v[200:203] offset:4656
ds_read_b64_tr_b16 v[64:65], v153 offset:0
ds_read_b64_tr_b16 v[66:67], v153 offset:576
ds_read_b64_tr_b16 v[68:69], v153 offset:2304
ds_read_b64_tr_b16 v[70:71], v153 offset:2880
ds_read_b64_tr_b16 v[72:73], v153 offset:64
ds_read_b64_tr_b16 v[74:75], v153 offset:640
ds_read_b64_tr_b16 v[76:77], v153 offset:2368
ds_read_b64_tr_b16 v[78:79], v153 offset:2944
ds_read_b64_tr_b16 v[80:81], v153 offset:4608
ds_read_b64_tr_b16 v[82:83], v153 offset:5184
ds_read_b64_tr_b16 v[84:85], v153 offset:6912
ds_read_b64_tr_b16 v[86:87], v153 offset:7488
ds_read_b64_tr_b16 v[88:89], v153 offset:4672
ds_read_b64_tr_b16 v[90:91], v153 offset:5248
ds_read_b64_tr_b16 v[92:93], v153 offset:6976
ds_read_b64_tr_b16 v[94:95], v153 offset:7552
s_add_u32 s45, s44, 0
s_waitcnt lgkmcnt(14)
buffer_store_dwordx4 v[64:67], v154, s[16:19], s45 offen sc1
s_add_u32 s45, s44, 1024
s_waitcnt lgkmcnt(12)
buffer_store_dwordx4 v[68:71], v154, s[16:19], s45 offen sc1
s_add_u32 s45, s44, 57344
s_waitcnt lgkmcnt(10)
buffer_store_dwordx4 v[72:75], v154, s[16:19], s45 offen sc1
s_add_u32 s45, s44, 58368
s_waitcnt lgkmcnt(8)
buffer_store_dwordx4 v[76:79], v154, s[16:19], s45 offen sc1
s_add_u32 s45, s44, 4096
s_waitcnt lgkmcnt(6)
buffer_store_dwordx4 v[80:83], v154, s[16:19], s45 offen sc1
s_add_u32 s45, s44, 5120
s_waitcnt lgkmcnt(4)
buffer_store_dwordx4 v[84:87], v154, s[16:19], s45 offen sc1
s_add_u32 s45, s44, 61440
s_waitcnt lgkmcnt(2)
buffer_store_dwordx4 v[88:91], v154, s[16:19], s45 offen sc1
s_add_u32 s45, s44, 62464
s_waitcnt lgkmcnt(0)
buffer_store_dwordx4 v[92:95], v154, s[16:19], s45 offen sc1
v_mov_b32 v8, 0
v_mov_b32 v9, 1
s_waitcnt vmcnt(0)
s_mov_b64 exec, 1
buffer_store_dword v9, v8, s[16:19], s55 offen sc1
s_mov_b64 exec, -1
s_barrier
s_mul_i32 s3, s4, 3584
s_add_u32 s45, s3, 0x30000
v_lshlrev_b32 v8, 7, v0
v_and_b32 v9, 3, v0
v_lshrrev_b32 v9, 1, v9
s_lshr_b32 s7, s6, 1
v_cmp_eq_u32 vcc, s7, v9
v_cmp_gt_u32 s[42:43], 28, v0
s_and_b64 s[42:43], s[42:43], vcc
s_mov_b64 exec, s[42:43]
s_mov_b32 s46, 0
LA_pu:
buffer_load_dword v9, v8, s[16:19], s45 offen sc1
s_waitcnt vmcnt(0)
v_cmp_ne_u32 vcc, 0, v9
s_cmp_eq_u64 vcc, exec
s_cbranch_scc1 LA_pu_ok
s_sleep 1
s_add_u32 s46, s46, 1
s_cmp_lt_u32 s46, 0x40000
s_cbranch_scc1 LA_pu
LA_pu_ok:
s_mov_b64 exec, -1
s_add_u32 s45, s32, 0
buffer_load_dwordx4 v[64:67], v154, s[16:19], s45 offen sc1
s_add_u32 s45, s32, 1024
buffer_load_dwordx4 v[68:71], v154, s[16:19], s45 offen sc1
s_add_u32 s45, s32, 2048
buffer_load_dwordx4 v[72:75], v154, s[16:19], s45 offen sc1
s_add_u32 s45, s32, 3072
buffer_load_dwordx4 v[76:79], v154, s[16:19], s45 offen sc1
s_add_u32 s45, s32, 4096
buffer_load_dwordx4 v[80:83], v154, s[16:19], s45 offen sc1
s_add_u32 s45, s32, 5120
buffer_load_dwordx4 v[84:87], v154, s[16:19], s45 offen sc1
s_add_u32 s45, s32, 6144
buffer_load_dwordx4 v[88:91], v154, s[16:19], s45 offen sc1
s_add_u32 s45, s32, 7168
buffer_load_dwordx4 v[92:95], v154, s[16:19], s45 offen sc1
s_add_u32 s45, s33, 0
buffer_load_dwordx4 v[96:99], v154, s[16:19], s45 offen sc1
s_add_u32 s45, s33, 1024
buffer_load_dwordx4 v[100:103], v154, s[16:19], s45 offen sc1
s_add_u32 s45, s33, 2048
buffer_load_dwordx4 v[104:107], v154, s[16:19], s45 offen sc1
s_add_u32 s45, s33, 3072
buffer_load_dwordx4 v[108:111], v154, s[16:19], s45 offen sc1
s_add_u32 s45, s33, 4096
buffer_load_dwordx4 v[112:115], v154, s[16:19], s45 offen sc1
s_add_u32 s45, s33, 5120
buffer_load_dwordx4 v[116:119], v154, s[16:19], s45 offen sc1
ds_read_b128 v[16:19], v142 offset:0
ds_read_b128 v[20:23], v142 offset:4096
ds_read_b128 v[24:27], v143 offset:0
ds_read_b128 v[28:31], v143 offset:4096
s_waitcnt vmcnt(13) lgkmcnt(2)
v_mfma_f32_32x32x16_bf16 v[220:235], v[16:19], v[64:67], v[220:235]
s_add_u32 s45, s33, 6144
buffer_load_dwordx4 v[120:123], v154, s[16:19], s45 offen sc1
v_mfma_f32_32x32x16_bf16 v[236:251], v[20:23], v[64:67], v[236:251]
ds_read_b128 v[16:19], v144 offset:0
ds_read_b128 v[20:23], v144 offset:4096
s_waitcnt vmcnt(13) lgkmcnt(2)
v_mfma_f32_32x32x16_bf16 v[220:235], v[24:27], v[68:71], v[220:235]
s_add_u32 s45, s33, 7168
buffer_load_dwordx4 v[124:127], v154, s[16:19], s45 offen sc1
v_mfma_f32_32x32x16_bf16 v[236:251], v[28:31], v[68:71], v[236:251]
ds_read_b128 v[24:27], v145 offset:0
ds_read_b128 v[28:31], v145 offset:4096
s_waitcnt vmcnt(13) lgkmcnt(2)
v_mfma_f32_32x32x16_bf16 v[220:235], v[16:19], v[72:75], v[220:235]
s_add_u32 s45, s34, 0
buffer_load_dwordx4 v[160:163], v154, s[16:19], s45 offen sc1
v_mfma_f32_32x32x16_bf16 v[236:251], v[20:23], v[72:75], v[236:251]
ds_read_b128 v[16:19], v146 offset:0
ds_read_b128 v[20:23], v146 offset:4096
s_waitcnt vmcnt(13) lgkmcnt(2)
v_mfma_f32_32x32x16_bf16 v[220:235], v[24:27], v[76:79], v[220:235]
s_add_u32 s45, s34, 1024
buffer_load_dwordx4 v[164:167], v154, s[16:19], s45 offen sc1
v_mfma_f32_32x32x16_bf16 v[236:251], v[28:31], v[76:79], v[236:251]
ds_read_b128 v[24:27], v147 offset:0
ds_read_b128 v[28:31], v147 offset:4096
s_waitcnt vmcnt(13) lgkmcnt(2)
v_mfma_f32_32x32x16_bf16 v[220:235], v[16:19], v[80:83], v[220:235]
s_add_u32 s45, s34, 2048
buffer_load_dwordx4 v[168:171], v154, s[16:19], s45 offen sc1
v_mfma_f32_32x32x16_bf16 v[236:251], v[20:23], v[80:83], v[236:251]
ds_read_b128 v[16:19], v148 offset:0
ds_read_b128 v[20:23], v148 offset:4096
s_waitcnt vmcnt(13) lgkmcnt(2)
v_mfma_f32_32x32x16_bf16 v[220:235], v[24:27], v[84:87], v[220:235]
s_add_u32 s45, s34, 3072
buffer_load_dwordx4 v[172:175], v154, s[16:19], s45 offen sc1
v_mfma_f32_32x32x16_bf16 v[236:251], v[28:31], v[84:87], v[236:251]
ds_read_b128 v[24:27], v149 offset:0
ds_read_b128 v[28:31], v149 offset:4096
s_waitcnt vmcnt(13) lgkmcnt(2)
v_mfma_f32_32x32x16_bf16 v[220:235], v[16:19], v[88:91], v[220:235]
s_add_u32 s45, s34, 4096
buffer_load_dwordx4 v[176:179], v154, s[16:19], s45 offen sc1
v_mfma_f32_32x32x16_bf16 v[236:251], v[20:23], v[88:91], v[236:251]
ds_read_b128 v[16:19], v142 offset:8192
ds_read_b128 v[20:23], v142 offset:12288
s_waitcnt vmcnt(13) lgkmcnt(2)
v_mfma_f32_32x32x16_bf16 v[220:235], v[24:27], v[92:95], v[220:235]
s_add_u32 s45, s34, 5120
buffer_load_dwordx4 v[180:183], v154, s[16:19], s45 offen sc1
v_mfma_f32_32x32x16_bf16 v[236:251], v[28:31], v[92:95], v[236:251]
ds_read_b128 v[24:27], v143 offset:8192
ds_read_b128 v[28:31], v143 offset:12288
s_waitcnt vmcnt(13) lgkmcnt(2)
v_mfma_f32_32x32x16_bf16 v[220:235], v[16:19], v[96:99], v[220:235]
s_add_u32 s45, s34, 6144
buffer_load_dwordx4 v[184:187], v154, s[16:19], s45 offen sc1
v_mfma_f32_32x32x16_bf16 v[236:251], v[20:23], v[96:99], v[236:251]
ds_read_b128 v[16:19], v144 offset:8192
ds_read_b128 v[20:23], v144 offset:12288
s_waitcnt vmcnt(13) lgkmcnt(2)
v_mfma_f32_32x32x16_bf16 v[220:235], v[24:27], v[100:103], v[220:235]
s_add_u32 s45, s34, 7168
buffer_load_dwordx4 v[188:191], v154, s[16:19], s45 offen sc1
v_mfma_f32_32x32x16_bf16 v[236:251], v[28:31], v[100:103], v[236:251]
ds_read_b128 v[24:27], v145 offset:8192
ds_read_b128 v[28:31], v145 offset:12288
s_waitcnt vmcnt(13) lgkmcnt(2)
v_mfma_f32_32x32x16_bf16 v[220:235], v[16:19], v[104:107], v[220:235]
s_add_u32 s45, s35, 0
buffer_load_dwordx4 v[64:67], v154, s[16:19], s45 offen sc1
v_mfma_f32_32x32x16_bf16 v[236:251], v[20:23], v[104:107], v[236:251]
ds_read_b128 v[16:19], v146 offset:8192
ds_read_b128 v[20:23], v146 offset:12288
s_waitcnt vmcnt(13) lgkmcnt(2)
v_mfma_f32_32x32x16_bf16 v[220:235], v[24:27], v[108:111], v[220:235]
s_add_u32 s45, s35, 1024
buffer_load_dwordx4 v[68:71], v154, s[16:19], s45 offen sc1
v_mfma_f32_32x32x16_bf16 v[236:251], v[28:31], v[108:111], v[236:251]
ds_read_b128 v[24:27], v147 offset:8192
ds_read_b128 v[28:31], v147 offset:12288
s_waitcnt vmcnt(13) lgkmcnt(2)
v_mfma_f32_32x32x16_bf16 v[220:235], v[16:19], v[112:115], v[220:235]
s_add_u32 s45, s35, 2048
buffer_load_dwordx4 v[72:75], v154, s[16:19], s45 offen sc1
v_mfma_f32_32x32x16_bf16 v[236:251], v[20:23], v[112:115], v[236:251]
ds_read_b128 v[16:19], v148 offset:8192
ds_read_b128 v[20:23], v148 offset:12288
s_waitcnt vmcnt(13) lgkmcnt(2)
v_mfma_f32_32x32x16_bf16 v[220:235], v[24:27], v[116:119], v[220:235]
s_add_u32 s45, s35, 3072
buffer_load_dwordx4 v[76:79], v154, s[16:19], s45 offen sc1
v_mfma_f32_32x32x16_bf16 v[236:251], v[28:31], v[116:119], v[236:251]
ds_read_b128 v[24:27], v149 offset:8192
ds_read_b128 v[28:31], v149 offset:12288
s_waitcnt vmcnt(13) lgkmcnt(2)
v_mfma_f32_32x32x16_bf16 v[220:235], v[16:19], v[120:123], v[220:235]
s_add_u32 s45, s35, 4096
buffer_load_dwordx4 v[80:83], v154, s[16:19], s45 offen sc1
v_mfma_f32_32x32x16_bf16 v[236:251], v[20:23], v[120:123], v[236:251]
ds_read_b128 v[16:19], v142 offset:16384
ds_read_b128 v[20:23], v142 offset:20480
s_waitcnt vmcnt(13) lgkmcnt(2)
v_mfma_f32_32x32x16_bf16 v[220:235], v[24:27], v[124:127], v[220:235]
s_add_u32 s45, s35, 5120
buffer_load_dwordx4 v[84:87], v154, s[16:19], s45 offen sc1
v_mfma_f32_32x32x16_bf16 v[236:251], v[28:31], v[124:127], v[236:251]
ds_read_b128 v[24:27], v143 offset:16384
ds_read_b128 v[28:31], v143 offset:20480
s_waitcnt vmcnt(13) lgkmcnt(2)
v_mfma_f32_32x32x16_bf16 v[220:235], v[16:19], v[160:163], v[220:235]
s_add_u32 s45, s35, 6144
buffer_load_dwordx4 v[88:91], v154, s[16:19], s45 offen sc1
v_mfma_f32_32x32x16_bf16 v[236:251], v[20:23], v[160:163], v[236:251]
ds_read_b128 v[16:19], v144 offset:16384
ds_read_b128 v[20:23], v144 offset:20480
s_waitcnt vmcnt(13) lgkmcnt(2)
v_mfma_f32_32x32x16_bf16 v[220:235], v[24:27], v[164:167], v[220:235]
s_add_u32 s45, s35, 7168
buffer_load_dwordx4 v[92:95], v154, s[16:19], s45 offen sc1
v_mfma_f32_32x32x16_bf16 v[236:251], v[28:31], v[164:167], v[236:251]
ds_read_b128 v[24:27], v145 offset:16384
ds_read_b128 v[28:31], v145 offset:20480
s_waitcnt vmcnt(13) lgkmcnt(2)
v_mfma_f32_32x32x16_bf16 v[220:235], v[16:19], v[168:171], v[220:235]
s_add_u32 s45, s36, 0
buffer_load_dwordx4 v[96:99], v154, s[16:19], s45 offen sc1
v_mfma_f32_32x32x16_bf16 v[236:251], v[20:23], v[168:171], v[236:251]
ds_read_b128 v[16:19], v146 offset:16384
ds_read_b128 v[20:23], v146 offset:20480
s_waitcnt vmcnt(13) lgkmcnt(2)
v_mfma_f32_32x32x16_bf16 v[220:235], v[24:27], v[172:175], v[220:235]
s_add_u32 s45, s36, 1024
buffer_load_dwordx4 v[100:103], v154, s[16:19], s45 offen sc1
v_mfma_f32_32x32x16_bf16 v[236:251], v[28:31], v[172:175], v[236:251]
ds_read_b128 v[24:27], v147 offset:16384
ds_read_b128 v[28:31], v147 offset:20480
s_waitcnt vmcnt(13) lgkmcnt(2)
v_mfma_f32_32x32x16_bf16 v[220:235], v[16:19], v[176:179], v[220:235]
s_add_u32 s45, s36, 2048
buffer_load_dwordx4 v[104:107], v154, s[16:19], s45 offen sc1
v_mfma_f32_32x32x16_bf16 v[236:251], v[20:23], v[176:179], v[236:251]
ds_read_b128 v[16:19], v148 offset:16384
ds_read_b128 v[20:23], v148 offset:20480
s_waitcnt vmcnt(13) lgkmcnt(2)
v_mfma_f32_32x32x16_bf16 v[220:235], v[24:27], v[180:183], v[220:235]
s_add_u32 s45, s36, 3072
buffer_load_dwordx4 v[108:111], v154, s[16:19], s45 offen sc1
v_mfma_f32_32x32x16_bf16 v[236:251], v[28:31], v[180:183], v[236:251]
ds_read_b128 v[24:27], v149 offset:16384
ds_read_b128 v[28:31], v149 offset:20480
s_waitcnt vmcnt(13) lgkmcnt(2)
v_mfma_f32_32x32x16_bf16 v[220:235], v[16:19], v[184:187], v[220:235]
s_add_u32 s45, s36, 4096
buffer_load_dwordx4 v[112:115], v154, s[16:19], s45 offen sc1
v_mfma_f32_32x32x16_bf16 v[236:251], v[20:23], v[184:187], v[236:251]
ds_read_b128 v[16:19], v142 offset:24576
ds_read_b128 v[20:23], v142 offset:28672
s_waitcnt vmcnt(13) lgkmcnt(2)
v_mfma_f32_32x32x16_bf16 v[220:235], v[24:27], v[188:191], v[220:235]
s_add_u32 s45, s36, 5120
buffer_load_dwordx4 v[116:119], v154, s[16:19], s45 offen sc1
v_mfma_f32_32x32x16_bf16 v[236:251], v[28:31], v[188:191], v[236:251]
ds_read_b128 v[24:27], v143 offset:24576
ds_read_b128 v[28:31], v143 offset:28672
s_waitcnt vmcnt(13) lgkmcnt(2)
v_mfma_f32_32x32x16_bf16 v[220:235], v[16:19], v[64:67], v[220:235]
s_add_u32 s45, s36, 6144
buffer_load_dwordx4 v[120:123], v154, s[16:19], s45 offen sc1
v_mfma_f32_32x32x16_bf16 v[236:251], v[20:23], v[64:67], v[236:251]
ds_read_b128 v[16:19], v144 offset:24576
ds_read_b128 v[20:23], v144 offset:28672
s_waitcnt vmcnt(13) lgkmcnt(2)
v_mfma_f32_32x32x16_bf16 v[220:235], v[24:27], v[68:71], v[220:235]
s_add_u32 s45, s36, 7168
buffer_load_dwordx4 v[124:127], v154, s[16:19], s45 offen sc1
v_mfma_f32_32x32x16_bf16 v[236:251], v[28:31], v[68:71], v[236:251]
ds_read_b128 v[24:27], v145 offset:24576
ds_read_b128 v[28:31], v145 offset:28672
s_waitcnt vmcnt(13) lgkmcnt(2)
v_mfma_f32_32x32x16_bf16 v[220:235], v[16:19], v[72:75], v[220:235]
s_add_u32 s45, s37, 0
buffer_load_dwordx4 v[160:163], v154, s[16:19], s45 offen sc1
v_mfma_f32_32x32x16_bf16 v[236:251], v[20:23], v[72:75], v[236:251]
ds_read_b128 v[16:19], v146 offset:24576
ds_read_b128 v[20:23], v146 offset:28672
s_waitcnt vmcnt(13) lgkmcnt(2)
v_mfma_f32_32x32x16_bf16 v[220:235], v[24:27], v[76:79], v[220:235]
s_add_u32 s45, s37, 1024
buffer_load_dwordx4 v[164:167], v154, s[16:19], s45 offen sc1
v_mfma_f32_32x32x16_bf16 v[236:251], v[28:31], v[76:79], v[236:251]
ds_read_b128 v[24:27], v147 offset:24576
ds_read_b128 v[28:31], v147 offset:28672
s_waitcnt vmcnt(13) lgkmcnt(2)
v_mfma_f32_32x32x16_bf16 v[220:235], v[16:19], v[80:83], v[220:235]
s_add_u32 s45, s37, 2048
buffer_load_dwordx4 v[168:171], v154, s[16:19], s45 offen sc1
v_mfma_f32_32x32x16_bf16 v[236:251], v[20:23], v[80:83], v[236:251]
ds_read_b128 v[16:19], v148 offset:24576
ds_read_b128 v[20:23], v148 offset:28672
s_waitcnt vmcnt(13) lgkmcnt(2)
v_mfma_f32_32x32x16_bf16 v[220:235], v[24:27], v[84:87], v[220:235]
s_add_u32 s45, s37, 3072
buffer_load_dwordx4 v[172:175], v154, s[16:19], s45 offen sc1
v_mfma_f32_32x32x16_bf16 v[236:251], v[28:31], v[84:87], v[236:251]
ds_read_b128 v[24:27], v149 offset:24576
ds_read_b128 v[28:31], v149 offset:28672
s_waitcnt vmcnt(13) lgkmcnt(2)
v_mfma_f32_32x32x16_bf16 v[220:235], v[16:19], v[88:91], v[220:235]
s_add_u32 s45, s37, 4096
buffer_load_dwordx4 v[176:179], v154, s[16:19], s45 offen sc1
v_mfma_f32_32x32x16_bf16 v[236:251], v[20:23], v[88:91], v[236:251]
ds_read_b128 v[16:19], v142 offset:32768
ds_read_b128 v[20:23], v142 offset:36864
s_waitcnt vmcnt(13) lgkmcnt(2)
v_mfma_f32_32x32x16_bf16 v[220:235], v[24:27], v[92:95], v[220:235]
s_add_u32 s45, s37, 5120
buffer_load_dwordx4 v[180:183], v154, s[16:19], s45 offen sc1
v_mfma_f32_32x32x16_bf16 v[236:251], v[28:31], v[92:95], v[236:251]
ds_read_b128 v[24:27], v143 offset:32768
ds_read_b128 v[28:31], v143 offset:36864
s_waitcnt vmcnt(13) lgkmcnt(2)
v_mfma_f32_32x32x16_bf16 v[220:235], v[16:19], v[96:99], v[220:235]
s_add_u32 s45, s37, 6144
buffer_load_dwordx4 v[184:187], v154, s[16:19], s45 offen sc1
v_mfma_f32_32x32x16_bf16 v[236:251], v[20:23], v[96:99], v[236:251]
ds_read_b128 v[16:19], v144 offset:32768
ds_read_b128 v[20:23], v144 offset:36864
s_waitcnt vmcnt(13) lgkmcnt(2)
v_mfma_f32_32x32x16_bf16 v[220:235], v[24:27], v[100:103], v[220:235]
s_add_u32 s45, s37, 7168
buffer_load_dwordx4 v[188:191], v154, s[16:19], s45 offen sc1
v_mfma_f32_32x32x16_bf16 v[236:251], v[28:31], v[100:103], v[236:251]
ds_read_b128 v[24:27], v145 offset:32768
ds_read_b128 v[28:31], v145 offset:36864
s_waitcnt vmcnt(13) lgkmcnt(2)
v_mfma_f32_32x32x16_bf16 v[220:235], v[16:19], v[104:107], v[220:235]
s_add_u32 s45, s38, 0
buffer_load_dwordx4 v[64:67], v154, s[16:19], s45 offen sc1
v_mfma_f32_32x32x16_bf16 v[236:251], v[20:23], v[104:107], v[236:251]
ds_read_b128 v[16:19], v146 offset:32768
ds_read_b128 v[20:23], v146 offset:36864
s_waitcnt vmcnt(13) lgkmcnt(2)
v_mfma_f32_32x32x16_bf16 v[220:235], v[24:27], v[108:111], v[220:235]
s_add_u32 s45, s38, 1024
buffer_load_dwordx4 v[68:71], v154, s[16:19], s45 offen sc1
v_mfma_f32_32x32x16_bf16 v[236:251], v[28:31], v[108:111], v[236:251]
ds_read_b128 v[24:27], v147 offset:32768
ds_read_b128 v[28:31], v147 offset:36864
s_waitcnt vmcnt(13) lgkmcnt(2)
v_mfma_f32_32x32x16_bf16 v[220:235], v[16:19], v[112:115], v[220:235]
s_add_u32 s45, s38, 2048
buffer_load_dwordx4 v[72:75], v154, s[16:19], s45 offen sc1
v_mfma_f32_32x32x16_bf16 v[236:251], v[20:23], v[112:115], v[236:251]
ds_read_b128 v[16:19], v148 offset:32768
ds_read_b128 v[20:23], v148 offset:36864
s_waitcnt vmcnt(13) lgkmcnt(2)
v_mfma_f32_32x32x16_bf16 v[220:235], v[24:27], v[116:119], v[220:235]
s_add_u32 s45, s38, 3072
buffer_load_dwordx4 v[76:79], v154, s[16:19], s45 offen sc1
v_mfma_f32_32x32x16_bf16 v[236:251], v[28:31], v[116:119], v[236:251]
ds_read_b128 v[24:27], v149 offset:32768
ds_read_b128 v[28:31], v149 offset:36864
s_waitcnt vmcnt(13) lgkmcnt(2)
v_mfma_f32_32x32x16_bf16 v[220:235], v[16:19], v[120:123], v[220:235]
s_add_u32 s45, s38, 4096
buffer_load_dwordx4 v[80:83], v154, s[16:19], s45 offen sc1
v_mfma_f32_32x32x16_bf16 v[236:251], v[20:23], v[120:123], v[236:251]
ds_read_b128 v[16:19], v142 offset:40960
ds_read_b128 v[20:23], v142 offset:45056
s_waitcnt vmcnt(13) lgkmcnt(2)
v_mfma_f32_32x32x16_bf16 v[220:235], v[24:27], v[124:127], v[220:235]
s_add_u32 s45, s38, 5120
buffer_load_dwordx4 v[84:87], v154, s[16:19], s45 offen sc1
v_mfma_f32_32x32x16_bf16 v[236:251], v[28:31], v[124:127], v[236:251]
ds_read_b128 v[24:27], v143 offset:40960
ds_read_b128 v[28:31], v143 offset:45056
s_waitcnt vmcnt(13) lgkmcnt(2)
v_mfma_f32_32x32x16_bf16 v[220:235], v[16:19], v[160:163], v[220:235]
s_add_u32 s45, s38, 6144
buffer_load_dwordx4 v[88:91], v154, s[16:19], s45 offen sc1
v_mfma_f32_32x32x16_bf16 v[236:251], v[20:23], v[160:163], v[236:251]
ds_read_b128 v[16:19], v144 offset:40960
ds_read_b128 v[20:23], v144 offset:45056
s_waitcnt vmcnt(13) lgkmcnt(2)
v_mfma_f32_32x32x16_bf16 v[220:235], v[24:27], v[164:167], v[220:235]
s_add_u32 s45, s38, 7168
buffer_load_dwordx4 v[92:95], v154, s[16:19], s45 offen sc1
v_mfma_f32_32x32x16_bf16 v[236:251], v[28:31], v[164:167], v[236:251]
ds_read_b128 v[24:27], v145 offset:40960
ds_read_b128 v[28:31], v145 offset:45056
s_waitcnt vmcnt(13) lgkmcnt(2)
v_mfma_f32_32x32x16_bf16 v[220:235], v[16:19], v[168:171], v[220:235]
v_mfma_f32_32x32x16_bf16 v[236:251], v[20:23], v[168:171], v[236:251]
ds_read_b128 v[16:19], v146 offset:40960
ds_read_b128 v[20:23], v146 offset:45056
s_waitcnt vmcnt(12) lgkmcnt(2)
v_mfma_f32_32x32x16_bf16 v[220:235], v[24:27], v[172:175], v[220:235]
v_mfma_f32_32x32x16_bf16 v[236:251], v[28:31], v[172:175], v[236:251]
ds_read_b128 v[24:27], v147 offset:40960
ds_read_b128 v[28:31], v147 offset:45056
s_waitcnt vmcnt(11) lgkmcnt(2)
v_mfma_f32_32x32x16_bf16 v[220:235], v[16:19], v[176:179], v[220:235]
v_mfma_f32_32x32x16_bf16 v[236:251], v[20:23], v[176:179], v[236:251]
ds_read_b128 v[16:19], v148 offset:40960
ds_read_b128 v[20:23], v148 offset:45056
s_waitcnt vmcnt(10) lgkmcnt(2)
v_mfma_f32_32x32x16_bf16 v[220:235], v[24:27], v[180:183], v[220:235]
v_mfma_f32_32x32x16_bf16 v[236:251], v[28:31], v[180:183], v[236:251]
ds_read_b128 v[24:27], v149 offset:40960
ds_read_b128 v[28:31], v149 offset:45056
s_waitcnt vmcnt(9) lgkmcnt(2)
v_mfma_f32_32x32x16_bf16 v[220:235], v[16:19], v[184:187], v[220:235]
v_mfma_f32_32x32x16_bf16 v[236:251], v[20:23], v[184:187], v[236:251]
ds_read_b128 v[16:19], v142 offset:49152
ds_read_b128 v[20:23], v142 offset:53248
s_waitcnt vmcnt(8) lgkmcnt(2)
v_mfma_f32_32x32x16_bf16 v[220:235], v[24:27], v[188:191], v[220:235]
v_mfma_f32_32x32x16_bf16 v[236:251], v[28:31], v[188:191], v[236:251]
ds_read_b128 v[24:27], v143 offset:49152
ds_read_b128 v[28:31], v143 offset:53248
s_waitcnt vmcnt(7) lgkmcnt(2)
v_mfma_f32_32x32x16_bf16 v[220:235], v[16:19], v[64:67], v[220:235]
v_mfma_f32_32x32x16_bf16 v[236:251], v[20:23], v[64:67], v[236:251]
ds_read_b128 v[16:19], v144 offset:49152
ds_read_b128 v[20:23], v144 offset:53248
s_waitcnt vmcnt(6) lgkmcnt(2)
v_mfma_f32_32x32x16_bf16 v[220:235], v[24:27], v[68:71], v[220:235]
v_mfma_f32_32x32x16_bf16 v[236:251], v[28:31], v[68:71], v[236:251]
ds_read_b128 v[24:27], v145 offset:49152
ds_read_b128 v[28:31], v145 offset:53248
s_waitcnt vmcnt(5) lgkmcnt(2)
v_mfma_f32_32x32x16_bf16 v[220:235], v[16:19], v[72:75], v[220:235]
v_mfma_f32_32x32x16_bf16 v[236:251], v[20:23], v[72:75], v[236:251]
ds_read_b128 v[16:19], v146 offset:49152
ds_read_b128 v[20:23], v146 offset:53248
s_waitcnt vmcnt(4) lgkmcnt(2)
v_mfma_f32_32x32x16_bf16 v[220:235], v[24:27], v[76:79], v[220:235]
v_mfma_f32_32x32x16_bf16 v[236:251], v[28:31], v[76:79], v[236:251]
ds_read_b128 v[24:27], v147 offset:49152
ds_read_b128 v[28:31], v147 offset:53248
s_waitcnt vmcnt(3) lgkmcnt(2)
v_mfma_f32_32x32x16_bf16 v[220:235], v[16:19], v[80:83], v[220:235]
v_mfma_f32_32x32x16_bf16 v[236:251], v[20:23], v[80:83], v[236:251]
ds_read_b128 v[16:19], v148 offset:49152
ds_read_b128 v[20:23], v148 offset:53248
s_waitcnt vmcnt(2) lgkmcnt(2)
v_mfma_f32_32x32x16_bf16 v[220:235], v[24:27], v[84:87], v[220:235]
v_mfma_f32_32x32x16_bf16 v[236:251], v[28:31], v[84:87], v[236:251]
ds_read_b128 v[24:27], v149 offset:49152
ds_read_b128 v[28:31], v149 offset:53248
s_waitcnt vmcnt(1) lgkmcnt(2)
v_mfma_f32_32x32x16_bf16 v[220:235], v[16:19], v[88:91], v[220:235]
v_mfma_f32_32x32x16_bf16 v[236:251], v[20:23], v[88:91], v[236:251]
s_waitcnt vmcnt(0) lgkmcnt(0)
v_mfma_f32_32x32x16_bf16 v[220:235], v[24:27], v[92:95], v[220:235]
v_mfma_f32_32x32x16_bf16 v[236:251], v[28:31], v[92:95], v[236:251]
s_nop 10
ds_write_b128 v204, v[220:223] offset:0
ds_write_b128 v204, v[224:227] offset:32
ds_write_b128 v204, v[228:231] offset:64
ds_write_b128 v204, v[232:235] offset:96
ds_write_b128 v204, v[236:239] offset:128
ds_write_b128 v204, v[240:243] offset:160
ds_write_b128 v204, v[244:247] offset:192
ds_write_b128 v204, v[248:251] offset:224
s_waitcnt lgkmcnt(0)
ds_read_b128 v[64:67], v205 offset:0
ds_read_b128 v[68:71], v205 offset:1088
ds_read_b128 v[72:75], v205 offset:2176
ds_read_b128 v[76:79], v205 offset:3264
ds_read_b128 v[80:83], v205 offset:4352
ds_read_b128 v[84:87], v205 offset:5440
ds_read_b128 v[88:91], v205 offset:6528
ds_read_b128 v[92:95], v205 offset:7616
s_add_u32 s45, s58, 0
s_waitcnt lgkmcnt(7)
buffer_store_dwordx4 v[64:67], v206, s[12:15], s45 offen sc1
s_add_u32 s45, s58, 7168
s_waitcnt lgkmcnt(6)
buffer_store_dwordx4 v[68:71], v206, s[12:15], s45 offen sc1
s_add_u32 s45, s58, 14336
s_waitcnt lgkmcnt(5)
buffer_store_dwordx4 v[72:75], v206, s[12:15], s45 offen sc1
s_add_u32 s45, s58, 21504
s_waitcnt lgkmcnt(4)
buffer_store_dwordx4 v[76:79], v206, s[12:15], s45 offen sc1
s_add_u32 s45, s58, 28672
s_waitcnt lgkmcnt(3)
buffer_store_dwordx4 v[80:83], v206, s[12:15], s45 offen sc1
s_add_u32 s45, s58, 35840
s_waitcnt lgkmcnt(2)
buffer_store_dwordx4 v[84:87], v206, s[12:15], s45 offen sc1
s_add_u32 s45, s58, 43008
s_waitcnt lgkmcnt(1)
buffer_store_dwordx4 v[88:91], v206, s[12:15], s45 offen sc1
s_add_u32 s45, s58, 50176
s_waitcnt lgkmcnt(0)
buffer_store_dwordx4 v[92:95], v206, s[12:15], s45 offen sc1
s_endpgm
L_AL:
s_sub_u32 s7, s6, 4
v_lshrrev_b32 v1, 3, v0
v_and_b32 v2, 7, v0
v_lshrrev_b32 v3, 1, v1
v_xor_b32 v4, v2, v3
v_xor_b32 v5, 4, v4
v_lshlrev_b32 v4, 4, v4
v_lshlrev_b32 v5, 4, v5
v_lshrrev_b32 v6, 2, v1
v_lshlrev_b32 v6, 5, v6
v_and_b32 v7, 1, v1
v_lshlrev_b32 v7, 4, v7
v_add_u32 v6, v6, v7
v_and_b32 v7, 1, v3
v_add_u32 v6, v6, v7
s_lshr_b32 s26, s7, 1
s_and_b32 s27, s7, 1
s_lshl_b32 s3, s26, 6
s_lshl_b32 s40, s27, 3
s_add_u32 s3, s3, s40
s_lshl_b32 s40, s4, 7
s_add_u32 s3, s3, s40
v_add_u32 v6, s3, v6
v_mul_u32_u24 v6, 896, v6
v_add_u32 v10, 0, v6
v_add_u32 v10, v10, v4
v_add_u32 v11, 1792, v6
v_add_u32 v11, v11, v5
v_add_u32 v12, 3584, v6
v_add_u32 v12, v12, v4
v_add_u32 v13, 5376, v6
v_add_u32 v13, v13, v5
s_lshl_b32 s3, s5, 6
s_lshl_b32 s40, s27, 5
s_add_u32 s3, s3, s40
v_add_u32 v6, s3, v1
v_mul_u32_u24 v6, 896, v6
v_add_u32 v14, 0, v6
v_add_u32 v14, v14, v4
v_add_u32 v15, 7168, v6
v_add_u32 v15, v15, v5
v_add_u32 v16, 14336, v6
v_add_u32 v16, v16, v4
v_add_u32 v17, 21504, v6
v_add_u32 v17, v17, v5
s_lshl_b32 s40, s7, 12
s_mov_b32 s47, 0
s_waitcnt lgkmcnt(0)
s_mov_b32 s8, s64
s_mov_b32 s9, s65
s_mov_b32 s10, 0x1c0000
s_mov_b32 s11, 0x20000
s_cmp_eq_u32 s26, 0
s_cselect_b32 s12, s70, s72
s_cselect_b32 s13, s71, s73
s_mov_b32 s14, 0x62000
s_mov_b32 s15, 0x20000
s_lshl_b32 s41, s47, 7
s_add_u32 s47, s47, 1
s_cmp_eq_u32 s47, 7
s_cselect_b32 s47, 0, s47
s_add_u32 m0, s40, 98304
s_nop 0
buffer_load_dwordx4 v10, s[8:11], s41 offen nt lds
s_add_u32 m0, s40, 99328
s_nop 0
buffer_load_dwordx4 v11, s[8:11], s41 offen nt lds
s_add_u32 m0, s40, 100352
s_nop 0
buffer_load_dwordx4 v12, s[8:11], s41 offen nt lds
s_add_u32 m0, s40, 101376
s_nop 0
buffer_load_dwordx4 v13, s[8:11], s41 offen nt lds
s_add_u32 m0, s40, 114688
s_nop 0
buffer_load_dwordx4 v14, s[12:15], s41 offen lds
s_add_u32 m0, s40, 115712
s_nop 0
buffer_load_dwordx4 v15, s[12:15], s41 offen lds
s_add_u32 m0, s40, 116736
s_nop 0
buffer_load_dwordx4 v16, s[12:15], s41 offen lds
s_add_u32 m0, s40, 117760
s_nop 0
buffer_load_dwordx4 v17, s[12:15], s41 offen lds
s_lshl_b32 s3, s5, 6
s_lshl_b32 s46, s7, 4
s_add_u32 s3, s3, s46
v_add_u32 v6, s3, v1
v_mul_u32_u24 v6, 896, v6
v_add_u32 v18, v6, v4
v_add_u32 v19, 7168, v6
v_add_u32 v19, v19, v5
s_and_b32 s24, s4, 3
v_mov_b32 v9, 0x7fffff00
s_mul_i32 s3, s5, 19
v_add_u32 v6, s3, v0
s_movk_i32 s25, 128
v_cmp_gt_u32 vcc, 19, v0
v_cmp_gt_u32 s[42:43], s25, v6
s_and_b64 vcc, vcc, s[42:43]
s_lshl_b32 s3, s4, 7
v_add_u32 v6, s3, v6
v_mul_u32_u24 v6, 896, v6
v_cndmask_b32 v22, v9, v6, vcc
s_and_b32 s25, s24, 1
s_lshl_b32 s25, s25, 5
s_lshl_b32 s3, s5, 6
s_add_u32 s3, s3, s25
v_add_u32 v6, s3, v0
v_mul_u32_u24 v6, 896, v6
v_cmp_gt_u32 vcc, 32, v0
s_nop 1
v_cndmask_b32 v23, v9, v6, vcc
s_cmp_eq_u32 s7, 0
s_cselect_b64 vcc, -1, 0
v_cndmask_b32 v22, v23, v22, vcc
s_cmp_lt_u32 s7, 2
s_cselect_b64 vcc, -1, 0
v_cndmask_b32 v22, v9, v22, vcc
s_mul_i32 s25, s24, 7
s_add_u32 s25, s25, s5
s_lshl_b32 s25, s25, 4
v_mul_u32_u24 v6, 37, v0
v_lshrrev_b32 v6, 8, v6
v_mul_u32_u24 v7, 7, v6
v_sub_u32 v7, v0, v7
v_add_u32 v6, s25, v6
v_mul_u32_u24 v6, 896, v6
v_lshlrev_b32 v7, 7, v7
v_add_u32 v6, v6, v7
s_and_b32 s25, s7, 1
s_mul_i32 s25, s25, 7168
v_add_u32 v6, s25, v6
v_cmp_gt_u32 vcc, 56, v0
s_nop 1
v_cndmask_b32 v23, v9, v6, vcc
s_and_b32 s3, s4, 2
s_cmp_eq_u32 s3, 0
s_cselect_b32 s24, s70, s72
s_cselect_b32 s25, s71, s73
s_mov_b32 s26, 0x62000
s_cmp_eq_u32 s7, 0
s_cselect_b32 s24, s64, s24
s_cselect_b32 s25, s65, s25
s_cselect_b32 s26, 0x1c0000, s26
s_mov_b32 s27, 0x20000
s_cmp_lt_u32 s7, 2
s_cselect_b32 s28, s74, s76
s_cselect_b32 s29, s75, s77
s_mov_b32 s30, 0x62000
s_mov_b32 s31, 0x20000
s_movk_i32 s41, 128
s_cmp_eq_u32 s7, 0
s_cbranch_scc1 LAL_pf1_a
buffer_load_dword v254, v22, s[24:27], s41 offen
s_branch LAL_pf1_b
LAL_pf1_a:
buffer_load_dword v254, v22, s[24:27], s41 offen nt
LAL_pf1_b:
s_movk_i32 s41, 256
s_cmp_eq_u32 s7, 0
s_cbranch_scc1 LAL_pf2_a
buffer_load_dword v254, v22, s[24:27], s41 offen
s_branch LAL_pf2_b
LAL_pf2_a:
buffer_load_dword v254, v22, s[24:27], s41 offen nt
LAL_pf2_b:
s_movk_i32 s41, 384
s_cmp_eq_u32 s7, 0
s_cbranch_scc1 LAL_pf3_a
buffer_load_dword v254, v22, s[24:27], s41 offen
s_branch LAL_pf3_b
LAL_pf3_a:
buffer_load_dword v254, v22, s[24:27], s41 offen nt
LAL_pf3_b:
s_mov_b32 s16, s74
s_mov_b32 s17, s75
s_mov_b32 s18, 0x62000
s_mov_b32 s19, 0x20000
s_mov_b32 s20, s76
s_mov_b32 s21, s77
s_mov_b32 s22, 0x62000
s_mov_b32 s23, 0x20000
s_lshl_b32 s49, s7, 11
s_mov_b32 s48, s5
s_lshl_b32 s32, s48, 7
s_add_u32 s48, s48, 1
s_cmp_eq_u32 s48, 7
s_cselect_b32 s48, 0, s48
s_lshl_b32 s33, s48, 7
s_add_u32 s48, s48, 1
s_cmp_eq_u32 s48, 7
s_cselect_b32 s48, 0, s48
s_lshl_b32 s34, s48, 7
s_add_u32 s48, s48, 1
s_cmp_eq_u32 s48, 7
s_cselect_b32 s48, 0, s48
s_lshl_b32 s35, s48, 7
s_add_u32 s48, s48, 1
s_cmp_eq_u32 s48, 7
s_cselect_b32 s48, 0, s48
s_lshl_b32 s36, s48, 7
s_add_u32 s48, s48, 1
s_cmp_eq_u32 s48, 7
s_cselect_b32 s48, 0, s48
s_lshl_b32 s37, s48, 7
s_add_u32 s48, s48, 1
s_cmp_eq_u32 s48, 7
s_cselect_b32 s48, 0, s48
s_lshl_b32 s38, s48, 7
s_add_u32 s48, s48, 1
s_cmp_eq_u32 s48, 7
s_cselect_b32 s48, 0, s48
s_waitcnt vmcnt(3)
s_barrier
s_lshl_b32 s41, s47, 7
s_add_u32 s47, s47, 1
s_cmp_eq_u32 s47, 7
s_cselect_b32 s47, 0, s47
s_add_u32 m0, s40, 131072
s_nop 0
buffer_load_dwordx4 v10, s[8:11], s41 offen nt lds
s_add_u32 m0, s40, 132096
s_nop 0
buffer_load_dwordx4 v11, s[8:11], s41 offen nt lds
s_add_u32 m0, s40, 133120
s_nop 0
buffer_load_dwordx4 v12, s[8:11], s41 offen nt lds
s_add_u32 m0, s40, 134144
s_nop 0
buffer_load_dwordx4 v13, s[8:11], s41 offen nt lds
s_add_u32 m0, s40, 147456
s_nop 0
buffer_load_dwordx4 v14, s[12:15], s41 offen lds
s_add_u32 m0, s40, 148480
s_nop 0
buffer_load_dwordx4 v15, s[12:15], s41 offen lds
s_add_u32 m0, s40, 149504
s_nop 0
buffer_load_dwordx4 v16, s[12:15], s41 offen lds
s_add_u32 m0, s40, 150528
s_nop 0
buffer_load_dwordx4 v17, s[12:15], s41 offen lds
s_lshl_b32 s41, s47, 7
s_add_u32 s47, s47, 1
s_cmp_eq_u32 s47, 7
s_cselect_b32 s47, 0, s47
s_add_u32 m0, s40, 0
s_nop 0
buffer_load_dwordx4 v10, s[8:11], s41 offen nt lds
s_add_u32 m0, s40, 1024
s_nop 0
buffer_load_dwordx4 v11, s[8:11], s41 offen nt lds
s_add_u32 m0, s40, 2048
s_nop 0
buffer_load_dwordx4 v12, s[8:11], s41 offen nt lds
s_add_u32 m0, s40, 3072
s_nop 0
buffer_load_dwordx4 v13, s[8:11], s41 offen nt lds
s_add_u32 m0, s40, 16384
s_nop 0
buffer_load_dwordx4 v14, s[12:15], s41 offen lds
s_add_u32 m0, s40, 17408
s_nop 0
buffer_load_dwordx4 v15, s[12:15], s41 offen lds
s_add_u32 m0, s40, 18432
s_nop 0
buffer_load_dwordx4 v16, s[12:15], s41 offen lds
s_add_u32 m0, s40, 19456
s_nop 0
buffer_load_dwordx4 v17, s[12:15], s41 offen lds
s_movk_i32 s41, 512
s_cmp_eq_u32 s7, 0
s_cbranch_scc1 LAL_pf4_a
buffer_load_dword v254, v22, s[24:27], s41 offen
s_branch LAL_pf4_b
LAL_pf4_a:
buffer_load_dword v254, v22, s[24:27], s41 offen nt
LAL_pf4_b:
s_waitcnt vmcnt(9)
s_barrier
s_lshl_b32 s41, s47, 7
s_add_u32 s47, s47, 1
s_cmp_eq_u32 s47, 7
s_cselect_b32 s47, 0, s47
s_add_u32 m0, s40, 32768
s_nop 0
buffer_load_dwordx4 v10, s[8:11], s41 offen nt lds
s_add_u32 m0, s40, 33792
s_nop 0
buffer_load_dwordx4 v11, s[8:11], s41 offen nt lds
s_add_u32 m0, s40, 34816
s_nop 0
buffer_load_dwordx4 v12, s[8:11], s41 offen nt lds
s_add_u32 m0, s40, 35840
s_nop 0
buffer_load_dwordx4 v13, s[8:11], s41 offen nt lds
s_add_u32 m0, s40, 49152
s_nop 0
buffer_load_dwordx4 v14, s[12:15], s41 offen lds
s_add_u32 m0, s40, 50176
s_nop 0
buffer_load_dwordx4 v15, s[12:15], s41 offen lds
s_add_u32 m0, s40, 51200
s_nop 0
buffer_load_dwordx4 v16, s[12:15], s41 offen lds
s_add_u32 m0, s40, 52224
s_nop 0
buffer_load_dwordx4 v17, s[12:15], s41 offen lds
s_movk_i32 s41, 640
s_cmp_eq_u32 s7, 0
s_cbranch_scc1 LAL_pf5_a
buffer_load_dword v254, v22, s[24:27], s41 offen
s_branch LAL_pf5_b
LAL_pf5_a:
buffer_load_dword v254, v22, s[24:27], s41 offen nt
LAL_pf5_b:
s_waitcnt vmcnt(10)
s_barrier
s_lshl_b32 s41, s47, 7
s_add_u32 s47, s47, 1
s_cmp_eq_u32 s47, 7
s_cselect_b32 s47, 0, s47
s_add_u32 m0, s40, 65536
s_nop 0
buffer_load_dwordx4 v10, s[8:11], s41 offen nt lds
s_add_u32 m0, s40, 66560
s_nop 0
buffer_load_dwordx4 v11, s[8:11], s41 offen nt lds
s_add_u32 m0, s40, 67584
s_nop 0
buffer_load_dwordx4 v12, s[8:11], s41 offen nt lds
s_add_u32 m0, s40, 68608
s_nop 0
buffer_load_dwordx4 v13, s[8:11], s41 offen nt lds
s_add_u32 m0, s40, 81920
s_nop 0
buffer_load_dwordx4 v14, s[12:15], s41 offen lds
s_add_u32 m0, s40, 82944
s_nop 0
buffer_load_dwordx4 v15, s[12:15], s41 offen lds
s_add_u32 m0, s40, 83968
s_nop 0
buffer_load_dwordx4 v16, s[12:15], s41 offen lds
s_add_u32 m0, s40, 84992
s_nop 0
buffer_load_dwordx4 v17, s[12:15], s41 offen lds
s_movk_i32 s41, 768
s_cmp_eq_u32 s7, 0
s_cbranch_scc1 LAL_pf6_a
buffer_load_dword v254, v22, s[24:27], s41 offen
s_branch LAL_pf6_b
LAL_pf6_a:
buffer_load_dword v254, v22, s[24:27], s41 offen nt
LAL_pf6_b:
s_waitcnt vmcnt(10)
s_barrier
s_lshl_b32 s41, s47, 7
s_add_u32 s47, s47, 1
s_cmp_eq_u32 s47, 7
s_cselect_b32 s47, 0, s47
s_add_u32 m0, s40, 98304
s_nop 0
buffer_load_dwordx4 v10, s[8:11], s41 offen nt lds
s_add_u32 m0, s40, 99328
s_nop 0
buffer_load_dwordx4 v11, s[8:11], s41 offen nt lds
s_add_u32 m0, s40, 100352
s_nop 0
buffer_load_dwordx4 v12, s[8:11], s41 offen nt lds
s_add_u32 m0, s40, 101376
s_nop 0
buffer_load_dwordx4 v13, s[8:11], s41 offen nt lds
s_add_u32 m0, s40, 114688
s_nop 0
buffer_load_dwordx4 v14, s[12:15], s41 offen lds
s_add_u32 m0, s40, 115712
s_nop 0
buffer_load_dwordx4 v15, s[12:15], s41 offen lds
s_add_u32 m0, s40, 116736
s_nop 0
buffer_load_dwordx4 v16, s[12:15], s41 offen lds
s_add_u32 m0, s40, 117760
s_nop 0
buffer_load_dwordx4 v17, s[12:15], s41 offen lds
s_waitcnt vmcnt(9)
s_barrier
v_lshlrev_b32 v20, 2, v0
global_load_dword v21, v20, s[90:91] sc1
s_lshl_b32 s41, s47, 7
s_add_u32 s47, s47, 1
s_cmp_eq_u32 s47, 7
s_cselect_b32 s47, 0, s47
s_add_u32 m0, s40, 131072
s_nop 0
buffer_load_dwordx4 v10, s[8:11], s41 offen nt lds
s_add_u32 m0, s40, 132096
s_nop 0
buffer_load_dwordx4 v11, s[8:11], s41 offen nt lds
s_add_u32 m0, s40, 133120
s_nop 0
buffer_load_dwordx4 v12, s[8:11], s41 offen nt lds
s_add_u32 m0, s40, 134144
s_nop 0
buffer_load_dwordx4 v13, s[8:11], s41 offen nt lds
s_add_u32 m0, s40, 147456
s_nop 0
buffer_load_dwordx4 v14, s[12:15], s41 offen lds
s_add_u32 m0, s40, 148480
s_nop 0
buffer_load_dwordx4 v15, s[12:15], s41 offen lds
s_add_u32 m0, s40, 149504
s_nop 0
buffer_load_dwordx4 v16, s[12:15], s41 offen lds
s_add_u32 m0, s40, 150528
s_nop 0
buffer_load_dwordx4 v17, s[12:15], s41 offen lds
s_waitcnt vmcnt(9)
s_barrier
s_add_u32 m0, s49, 0
s_nop 0
buffer_load_dwordx4 v18, s[16:19], s32 offen lds
s_add_u32 m0, s49, 1024
s_nop 0
buffer_load_dwordx4 v19, s[16:19], s32 offen lds
s_add_u32 m0, s49, 8192
s_nop 0
buffer_load_dwordx4 v18, s[16:19], s33 offen lds
s_add_u32 m0, s49, 9216
s_nop 0
buffer_load_dwordx4 v19, s[16:19], s33 offen lds
s_add_u32 m0, s49, 16384
s_nop 0
buffer_load_dwordx4 v18, s[16:19], s34 offen lds
s_add_u32 m0, s49, 17408
s_nop 0
buffer_load_dwordx4 v19, s[16:19], s34 offen lds
s_add_u32 m0, s49, 24576
s_nop 0
buffer_load_dwordx4 v18, s[16:19], s35 offen lds
s_add_u32 m0, s49, 25600
s_nop 0
buffer_load_dwordx4 v19, s[16:19], s35 offen lds
s_waitcnt vmcnt(8)
s_barrier
s_add_u32 m0, s49, 32768
s_nop 0
buffer_load_dwordx4 v18, s[16:19], s36 offen lds
s_add_u32 m0, s49, 33792
s_nop 0
buffer_load_dwordx4 v19, s[16:19], s36 offen lds
s_add_u32 m0, s49, 40960
s_nop 0
buffer_load_dwordx4 v18, s[16:19], s37 offen lds
s_add_u32 m0, s49, 41984
s_nop 0
buffer_load_dwordx4 v19, s[16:19], s37 offen lds
s_add_u32 m0, s49, 49152
s_nop 0
buffer_load_dwordx4 v18, s[16:19], s38 offen lds
s_add_u32 m0, s49, 50176
s_nop 0
buffer_load_dwordx4 v19, s[16:19], s38 offen lds
s_add_u32 m0, s49, 57344
s_nop 0
buffer_load_dwordx4 v18, s[20:23], s32 offen lds
s_add_u32 m0, s49, 58368
s_nop 0
buffer_load_dwordx4 v19, s[20:23], s32 offen lds
s_add_u32 m0, s49, 65536
s_nop 0
buffer_load_dwordx4 v18, s[20:23], s33 offen lds
s_add_u32 m0, s49, 66560
s_nop 0
buffer_load_dwordx4 v19, s[20:23], s33 offen lds
s_add_u32 m0, s49, 73728
s_nop 0
buffer_load_dwordx4 v18, s[20:23], s34 offen lds
s_add_u32 m0, s49, 74752
s_nop 0
buffer_load_dwordx4 v19, s[20:23], s34 offen lds
s_add_u32 m0, s49, 81920
s_nop 0
buffer_load_dwordx4 v18, s[20:23], s35 offen lds
s_add_u32 m0, s49, 82944
s_nop 0
buffer_load_dwordx4 v19, s[20:23], s35 offen lds
s_add_u32 m0, s49, 90112
s_nop 0
buffer_load_dwordx4 v18, s[20:23], s36 offen lds
s_add_u32 m0, s49, 91136
s_nop 0
buffer_load_dwordx4 v19, s[20:23], s36 offen lds
s_mov_b32 s46, 0
s_branch LAL_zd_chk
LAL_zd:
s_sleep 1
global_load_dword v21, v20, s[90:91] sc1
s_waitcnt vmcnt(0)
LAL_zd_chk:
v_cmp_ne_u32 vcc, 0, v21
s_and_b32 s42, vcc_lo, 0xffff
s_cmp_eq_u32 s42, 0xffff
s_cbranch_scc1 LAL_zd_ok
s_add_u32 s46, s46, 1
s_cmp_lt_u32 s46, 0x40000
s_cbranch_scc1 LAL_zd
LAL_zd_ok:
s_barrier
s_add_u32 m0, s49, 98304
s_nop 0
buffer_load_dwordx4 v18, s[20:23], s37 offen lds
s_add_u32 m0, s49, 99328
s_nop 0
buffer_load_dwordx4 v19, s[20:23], s37 offen lds
s_add_u32 m0, s49, 106496
s_nop 0
buffer_load_dwordx4 v18, s[20:23], s38 offen lds
s_add_u32 m0, s49, 107520
s_nop 0
buffer_load_dwordx4 v19, s[20:23], s38 offen lds
s_barrier
s_waitcnt vmcnt(0)
s_barrier
s_endpgm
L_H:
s_lshl_b32 s5, s3, 2
s_add_u32 s5, s5, s7
s_sub_u32 s5, s5, 28
s_waitcnt lgkmcnt(0)
s_mov_b32 s16, s92
s_mov_b32 s17, s93
s_mov_b32 s18, 0x40000
s_mov_b32 s19, 0x20000
v_mov_b32 v4, 0
v_mov_b32 v5, 0
v_mov_b32 v6, 0
v_mov_b32 v7, 0
v_lshlrev_b32 v1, 4, v0
s_lshl_b32 s3, s5, 14
s_lshl_b32 s7, s6, 10
s_add_u32 s44, s3, s7
buffer_store_dwordx4 v[4:7], v1, s[16:19], s44 offen sc1
s_add_u32 s44, s44, 8192
buffer_store_dwordx4 v[4:7], v1, s[16:19], s44 offen sc1
s_waitcnt vmcnt(0)
s_barrier
s_cmp_eq_u32 s6, 0
s_cbranch_scc0 LH_end
s_lshl_b32 s3, s5, 2
v_mov_b32 v2, s3
v_mov_b32 v3, 1
s_mov_b64 exec, 1
global_store_dword v2, v3, s[90:91] sc1
s_mov_b64 exec, -1
LH_end:
s_lshl_b32 s3, s6, 6
v_add_u32 v1, s3, v0
v_mul_u32_u24 v2, 0x2493, v1
v_lshrrev_b32 v2, 16, v2
v_mul_u32_u24 v3, 7, v2
v_sub_u32 v3, v1, v3
v_lshlrev_b32 v3, 7, v3
s_mul_i32 s3, s5, 28
v_add_u32 v2, s3, v2
v_mov_b32 v9, 0x7fffff00
s_movk_i32 s3, 196
v_cmp_gt_u32 vcc, s3, v1
v_mul_u32_u24 v4, 2688, v2
v_add_u32 v4, v4, v3
v_cndmask_b32 v4, v9, v4, vcc
v_mul_u32_u24 v5, 896, v2
v_add_u32 v5, v5, v3
v_cndmask_b32 v5, v9, v5, vcc
s_mov_b32 s8, s84
s_mov_b32 s9, s85
s_mov_b32 s10, 0x126000
s_mov_b32 s11, 0x20000
s_mov_b32 s12, s74
s_mov_b32 s13, s75
s_mov_b32 s14, 0x62000
s_mov_b32 s15, 0x20000
s_mov_b32 s16, s76
s_mov_b32 s17, s77
s_mov_b32 s18, 0x62000
s_mov_b32 s19, 0x20000
s_mov_b32 s20, s86
s_mov_b32 s21, s87
s_mov_b32 s22, 0x62000
s_mov_b32 s23, 0x20000
s_cmp_ge_u32 s6, 4
s_cbranch_scc1 LH_pfend
buffer_load_dword v10, v4, s[8:11], 0 offen
buffer_load_dword v11, v5, s[12:15], 0 offen
buffer_load_dword v12, v5, s[16:19], 0 offen
buffer_load_dword v13, v5, s[20:23], 0 offen
s_waitcnt vmcnt(0)
LH_pfend:
s_endpgm
L_B:
s_sub_u32 s3, s3, 4
s_lshl_b32 s4, s3, 2
s_lshr_b32 s46, s7, 3
s_add_u32 s4, s4, s46
s_and_b32 s5, s7, 7
s_cmp_ge_u32 s6, 4
s_cbranch_scc1 L_BL
v_and_b32 v1, 31, v0
v_lshrrev_b32 v2, 5, v0
v_lshrrev_b32 v3, 1, v1
v_and_b32 v3, 7, v3
s_lshr_b32 s7, s6, 1
s_lshl_b32 s7, s7, 13
v_lshlrev_b32 v4, 7, v1
v_add_u32 v5, 0, v2
v_xor_b32 v5, v5, v3
v_lshlrev_b32 v5, 4, v5
v_add_u32 v5, v5, v4
v_add_u32 v16, s7, v5
v_add_u32 v5, 2, v2
v_xor_b32 v5, v5, v3
v_lshlrev_b32 v5, 4, v5
v_add_u32 v5, v5, v4
v_add_u32 v17, s7, v5
v_add_u32 v5, 4, v2
v_xor_b32 v5, v5, v3
v_lshlrev_b32 v5, 4, v5
v_add_u32 v5, v5, v4
v_add_u32 v18, s7, v5
v_add_u32 v5, 6, v2
v_xor_b32 v5, v5, v3
v_lshlrev_b32 v5, 4, v5
v_add_u32 v5, v5, v4
v_add_u32 v19, s7, v5
v_lshrrev_b32 v4, 4, v0
v_and_b32 v5, 1, v4
v_lshrrev_b32 v4, 1, v4
v_and_b32 v6, 15, v0
v_lshrrev_b32 v6, 2, v6
v_and_b32 v7, 3, v0
v_lshlrev_b32 v4, 3, v4
v_add_u32 v4, v4, v6
v_lshlrev_b32 v4, 7, v4
v_lshlrev_b32 v5, 5, v5
v_lshlrev_b32 v7, 3, v7
v_add_u32 v5, v5, v7
s_and_b32 s3, s6, 1
s_mul_i32 s3, s3, 56
v_add_u32 v5, s3, v5
v_lshrrev_b32 v6, 1, v6
v_lshlrev_b32 v6, 6, v6
v_xor_b32 v5, v5, v6
v_add_u32 v4, v4, v5
v_add_u32 v20, 114688, v4
s_waitcnt lgkmcnt(0)
v_add_u32 v21, 0, v16
v_add_u32 v22, 0, v17
v_add_u32 v23, 0, v18
v_add_u32 v24, 0, v19
s_mov_b32 s50, 0x3fb8aa3b
s_mov_b32 s51, 0x3fb8aa3b
s_mov_b32 s52, 0x358637bd
v_and_b32 v1, 31, v0
v_cmp_lt_u32 s[54:55], 27, v1
v_cmp_eq_u32 vcc, 28, v1
v_mov_b32 v12, 0
v_mov_b32 v3, 0x3f803f80
v_cndmask_b32 v12, v12, v3, vcc
s_mov_b32 s56, 0
s_mov_b32 s57, -1
s_mov_b32 s16, s92
s_mov_b32 s17, s93
s_mov_b32 s18, 0x800000
s_mov_b32 s19, 0x20000
s_barrier
ds_read_b128 v[32:35], v21 offset:0
ds_read_b128 v[36:39], v21 offset:4096
ds_read_b64_tr_b16 v[40:41], v20 offset:0
ds_read_b64_tr_b16 v[42:43], v20 offset:512
ds_read_b64_tr_b16 v[44:45], v20 offset:8192
ds_read_b64_tr_b16 v[46:47], v20 offset:8704
ds_read_b128 v[48:51], v22 offset:0
ds_read_b128 v[52:55], v22 offset:4096
ds_read_b64_tr_b16 v[56:57], v20 offset:2048
ds_read_b64_tr_b16 v[58:59], v20 offset:2560
ds_read_b64_tr_b16 v[60:61], v20 offset:10240
ds_read_b64_tr_b16 v[62:63], v20 offset:10752
s_waitcnt lgkmcnt(6)
v_mfma_f32_32x32x16_bf16 v[64:79], v[32:35], v[40:43], 0
v_mfma_f32_32x32x16_bf16 v[96:111], v[32:35], v[44:47], 0
v_mfma_f32_32x32x16_bf16 v[80:95], v[36:39], v[40:43], 0
v_mfma_f32_32x32x16_bf16 v[112:127], v[36:39], v[44:47], 0
ds_read_b128 v[32:35], v23 offset:0
ds_read_b128 v[36:39], v23 offset:4096
ds_read_b64_tr_b16 v[40:41], v20 offset:4096
ds_read_b64_tr_b16 v[42:43], v20 offset:4608
ds_read_b64_tr_b16 v[44:45], v20 offset:12288
ds_read_b64_tr_b16 v[46:47], v20 offset:12800
s_waitcnt lgkmcnt(6)
v_mfma_f32_32x32x16_bf16 v[64:79], v[48:51], v[56:59], v[64:79]
v_mfma_f32_32x32x16_bf16 v[96:111], v[48:51], v[60:63], v[96:111]
v_mfma_f32_32x32x16_bf16 v[80:95], v[52:55], v[56:59], v[80:95]
v_mfma_f32_32x32x16_bf16 v[112:127], v[52:55], v[60:63], v[112:127]
ds_read_b128 v[48:51], v24 offset:0
ds_read_b128 v[52:55], v24 offset:4096
ds_read_b64_tr_b16 v[56:57], v20 offset:6144
ds_read_b64_tr_b16 v[58:59], v20 offset:6656
ds_read_b64_tr_b16 v[60:61], v20 offset:14336
ds_read_b64_tr_b16 v[62:63], v20 offset:14848
s_waitcnt lgkmcnt(6)
v_mfma_f32_32x32x16_bf16 v[64:79], v[32:35], v[40:43], v[64:79]
v_mfma_f32_32x32x16_bf16 v[96:111], v[32:35], v[44:47], v[96:111]
v_mfma_f32_32x32x16_bf16 v[80:95], v[36:39], v[40:43], v[80:95]
v_mfma_f32_32x32x16_bf16 v[112:127], v[36:39], v[44:47], v[112:127]
s_waitcnt lgkmcnt(0)
v_add_u32 v21, 16384, v16
v_add_u32 v22, 16384, v17
v_add_u32 v23, 16384, v18
v_add_u32 v24, 16384, v19
s_barrier
ds_read_b128 v[32:35], v21 offset:0
ds_read_b128 v[36:39], v21 offset:4096
ds_read_b64_tr_b16 v[40:41], v20 offset:16384
ds_read_b64_tr_b16 v[42:43], v20 offset:16896
ds_read_b64_tr_b16 v[44:45], v20 offset:24576
ds_read_b64_tr_b16 v[46:47], v20 offset:25088
v_mfma_f32_32x32x16_bf16 v[64:79], v[48:51], v[56:59], v[64:79]
v_mfma_f32_32x32x16_bf16 v[96:111], v[48:51], v[60:63], v[96:111]
v_mfma_f32_32x32x16_bf16 v[80:95], v[52:55], v[56:59], v[80:95]
v_mfma_f32_32x32x16_bf16 v[112:127], v[52:55], v[60:63], v[112:127]
ds_read_b128 v[48:51], v22 offset:0
ds_read_b128 v[52:55], v22 offset:4096
ds_read_b64_tr_b16 v[56:57], v20 offset:18432
ds_read_b64_tr_b16 v[58:59], v20 offset:18944
ds_read_b64_tr_b16 v[60:61], v20 offset:26624
ds_read_b64_tr_b16 v[62:63], v20 offset:27136
s_waitcnt lgkmcnt(6)
v_mfma_f32_32x32x16_bf16 v[64:79], v[32:35], v[40:43], v[64:79]
v_mfma_f32_32x32x16_bf16 v[96:111], v[32:35], v[44:47], v[96:111]
v_mfma_f32_32x32x16_bf16 v[80:95], v[36:39], v[40:43], v[80:95]
v_mfma_f32_32x32x16_bf16 v[112:127], v[36:39], v[44:47], v[112:127]
ds_read_b128 v[32:35], v23 offset:0
ds_read_b128 v[36:39], v23 offset:4096
ds_read_b64_tr_b16 v[40:41], v20 offset:20480
ds_read_b64_tr_b16 v[42:43], v20 offset:20992
ds_read_b64_tr_b16 v[44:45], v20 offset:28672
ds_read_b64_tr_b16 v[46:47], v20 offset:29184
s_waitcnt lgkmcnt(6)
v_mfma_f32_32x32x16_bf16 v[64:79], v[48:51], v[56:59], v[64:79]
v_mfma_f32_32x32x16_bf16 v[96:111], v[48:51], v[60:63], v[96:111]
v_mfma_f32_32x32x16_bf16 v[80:95], v[52:55], v[56:59], v[80:95]
v_mfma_f32_32x32x16_bf16 v[112:127], v[52:55], v[60:63], v[112:127]
ds_read_b128 v[48:51], v24 offset:0
ds_read_b128 v[52:55], v24 offset:4096
ds_read_b64_tr_b16 v[56:57], v20 offset:22528
ds_read_b64_tr_b16 v[58:59], v20 offset:23040
ds_read_b64_tr_b16 v[60:61], v20 offset:30720
ds_read_b64_tr_b16 v[62:63], v20 offset:31232
s_waitcnt lgkmcnt(6)
v_mfma_f32_32x32x16_bf16 v[64:79], v[32:35], v[40:43], v[64:79]
v_mfma_f32_32x32x16_bf16 v[96:111], v[32:35], v[44:47], v[96:111]
v_mfma_f32_32x32x16_bf16 v[80:95], v[36:39], v[40:43], v[80:95]
v_mfma_f32_32x32x16_bf16 v[112:127], v[36:39], v[44:47], v[112:127]
s_waitcnt lgkmcnt(0)
v_add_u32 v21, 32768, v16
v_add_u32 v22, 32768, v17
v_add_u32 v23, 32768, v18
v_add_u32 v24, 32768, v19
s_barrier
ds_read_b128 v[32:35], v21 offset:0
ds_read_b128 v[36:39], v21 offset:4096
ds_read_b64_tr_b16 v[40:41], v20 offset:32768
ds_read_b64_tr_b16 v[42:43], v20 offset:33280
ds_read_b64_tr_b16 v[44:45], v20 offset:40960
ds_read_b64_tr_b16 v[46:47], v20 offset:41472
v_mfma_f32_32x32x16_bf16 v[64:79], v[48:51], v[56:59], v[64:79]
v_mfma_f32_32x32x16_bf16 v[96:111], v[48:51], v[60:63], v[96:111]
v_mfma_f32_32x32x16_bf16 v[80:95], v[52:55], v[56:59], v[80:95]
v_mfma_f32_32x32x16_bf16 v[112:127], v[52:55], v[60:63], v[112:127]
ds_read_b128 v[48:51], v22 offset:0
ds_read_b128 v[52:55], v22 offset:4096
ds_read_b64_tr_b16 v[56:57], v20 offset:34816
ds_read_b64_tr_b16 v[58:59], v20 offset:35328
ds_read_b64_tr_b16 v[60:61], v20 offset:43008
ds_read_b64_tr_b16 v[62:63], v20 offset:43520
s_waitcnt lgkmcnt(6)
v_mfma_f32_32x32x16_bf16 v[64:79], v[32:35], v[40:43], v[64:79]
v_mfma_f32_32x32x16_bf16 v[96:111], v[32:35], v[44:47], v[96:111]
v_mfma_f32_32x32x16_bf16 v[80:95], v[36:39], v[40:43], v[80:95]
v_mfma_f32_32x32x16_bf16 v[112:127], v[36:39], v[44:47], v[112:127]
ds_read_b128 v[32:35], v23 offset:0
ds_read_b128 v[36:39], v23 offset:4096
ds_read_b64_tr_b16 v[40:41], v20 offset:36864
ds_read_b64_tr_b16 v[42:43], v20 offset:37376
ds_read_b64_tr_b16 v[44:45], v20 offset:45056
ds_read_b64_tr_b16 v[46:47], v20 offset:45568
s_waitcnt lgkmcnt(6)
v_mfma_f32_32x32x16_bf16 v[64:79], v[48:51], v[56:59], v[64:79]
v_mfma_f32_32x32x16_bf16 v[96:111], v[48:51], v[60:63], v[96:111]
v_mfma_f32_32x32x16_bf16 v[80:95], v[52:55], v[56:59], v[80:95]
v_mfma_f32_32x32x16_bf16 v[112:127], v[52:55], v[60:63], v[112:127]
ds_read_b128 v[48:51], v24 offset:0
ds_read_b128 v[52:55], v24 offset:4096
ds_read_b64_tr_b16 v[56:57], v20 offset:38912
ds_read_b64_tr_b16 v[58:59], v20 offset:39424
ds_read_b64_tr_b16 v[60:61], v20 offset:47104
ds_read_b64_tr_b16 v[62:63], v20 offset:47616
s_waitcnt lgkmcnt(6)
v_mfma_f32_32x32x16_bf16 v[64:79], v[32:35], v[40:43], v[64:79]
v_mfma_f32_32x32x16_bf16 v[96:111], v[32:35], v[44:47], v[96:111]
v_mfma_f32_32x32x16_bf16 v[80:95], v[36:39], v[40:43], v[80:95]
v_mfma_f32_32x32x16_bf16 v[112:127], v[36:39], v[44:47], v[112:127]
s_waitcnt lgkmcnt(0)
v_add_u32 v21, 49152, v16
v_add_u32 v22, 49152, v17
v_add_u32 v23, 49152, v18
v_add_u32 v24, 49152, v19
s_barrier
ds_read_b128 v[32:35], v21 offset:0
ds_read_b128 v[36:39], v21 offset:4096
ds_read_b64_tr_b16 v[40:41], v20 offset:0
ds_read_b64_tr_b16 v[42:43], v20 offset:512
ds_read_b64_tr_b16 v[44:45], v20 offset:8192
ds_read_b64_tr_b16 v[46:47], v20 offset:8704
v_mfma_f32_32x32x16_bf16 v[64:79], v[48:51], v[56:59], v[64:79]
v_mfma_f32_32x32x16_bf16 v[96:111], v[48:51], v[60:63], v[96:111]
v_mfma_f32_32x32x16_bf16 v[80:95], v[52:55], v[56:59], v[80:95]
v_mfma_f32_32x32x16_bf16 v[112:127], v[52:55], v[60:63], v[112:127]
ds_read_b128 v[48:51], v22 offset:0
ds_read_b128 v[52:55], v22 offset:4096
ds_read_b64_tr_b16 v[56:57], v20 offset:2048
ds_read_b64_tr_b16 v[58:59], v20 offset:2560
ds_read_b64_tr_b16 v[60:61], v20 offset:10240
ds_read_b64_tr_b16 v[62:63], v20 offset:10752
s_waitcnt lgkmcnt(6)
v_mfma_f32_32x32x16_bf16 v[64:79], v[32:35], v[40:43], v[64:79]
v_mfma_f32_32x32x16_bf16 v[96:111], v[32:35], v[44:47], v[96:111]
v_mfma_f32_32x32x16_bf16 v[80:95], v[36:39], v[40:43], v[80:95]
v_mfma_f32_32x32x16_bf16 v[112:127], v[36:39], v[44:47], v[112:127]
ds_read_b128 v[32:35], v23 offset:0
ds_read_b128 v[36:39], v23 offset:4096
ds_read_b64_tr_b16 v[40:41], v20 offset:4096
ds_read_b64_tr_b16 v[42:43], v20 offset:4608
ds_read_b64_tr_b16 v[44:45], v20 offset:12288
ds_read_b64_tr_b16 v[46:47], v20 offset:12800
s_waitcnt lgkmcnt(6)
v_mfma_f32_32x32x16_bf16 v[64:79], v[48:51], v[56:59], v[64:79]
v_mfma_f32_32x32x16_bf16 v[96:111], v[48:51], v[60:63], v[96:111]
v_mfma_f32_32x32x16_bf16 v[80:95], v[52:55], v[56:59], v[80:95]
v_mfma_f32_32x32x16_bf16 v[112:127], v[52:55], v[60:63], v[112:127]
ds_read_b128 v[48:51], v24 offset:0
ds_read_b128 v[52:55], v24 offset:4096
ds_read_b64_tr_b16 v[56:57], v20 offset:6144
ds_read_b64_tr_b16 v[58:59], v20 offset:6656
ds_read_b64_tr_b16 v[60:61], v20 offset:14336
ds_read_b64_tr_b16 v[62:63], v20 offset:14848
s_waitcnt lgkmcnt(6)
v_mfma_f32_32x32x16_bf16 v[64:79], v[32:35], v[40:43], v[64:79]
v_mfma_f32_32x32x16_bf16 v[96:111], v[32:35], v[44:47], v[96:111]
v_mfma_f32_32x32x16_bf16 v[80:95], v[36:39], v[40:43], v[80:95]
v_mfma_f32_32x32x16_bf16 v[112:127], v[36:39], v[44:47], v[112:127]
s_waitcnt lgkmcnt(0)
v_add_u32 v21, 65536, v16
v_add_u32 v22, 65536, v17
v_add_u32 v23, 65536, v18
v_add_u32 v24, 65536, v19
s_barrier
ds_read_b128 v[32:35], v21 offset:0
ds_read_b128 v[36:39], v21 offset:4096
ds_read_b64_tr_b16 v[40:41], v20 offset:16384
ds_read_b64_tr_b16 v[42:43], v20 offset:16896
ds_read_b64_tr_b16 v[44:45], v20 offset:24576
ds_read_b64_tr_b16 v[46:47], v20 offset:25088
v_mfma_f32_32x32x16_bf16 v[64:79], v[48:51], v[56:59], v[64:79]
v_mfma_f32_32x32x16_bf16 v[96:111], v[48:51], v[60:63], v[96:111]
v_mfma_f32_32x32x16_bf16 v[80:95], v[52:55], v[56:59], v[80:95]
v_mfma_f32_32x32x16_bf16 v[112:127], v[52:55], v[60:63], v[112:127]
ds_read_b128 v[48:51], v22 offset:0
ds_read_b128 v[52:55], v22 offset:4096
ds_read_b64_tr_b16 v[56:57], v20 offset:18432
ds_read_b64_tr_b16 v[58:59], v20 offset:18944
ds_read_b64_tr_b16 v[60:61], v20 offset:26624
ds_read_b64_tr_b16 v[62:63], v20 offset:27136
s_waitcnt lgkmcnt(6)
v_mfma_f32_32x32x16_bf16 v[64:79], v[32:35], v[40:43], v[64:79]
v_mfma_f32_32x32x16_bf16 v[96:111], v[32:35], v[44:47], v[96:111]
v_mfma_f32_32x32x16_bf16 v[80:95], v[36:39], v[40:43], v[80:95]
v_mfma_f32_32x32x16_bf16 v[112:127], v[36:39], v[44:47], v[112:127]
ds_read_b128 v[32:35], v23 offset:0
ds_read_b128 v[36:39], v23 offset:4096
ds_read_b64_tr_b16 v[40:41], v20 offset:20480
ds_read_b64_tr_b16 v[42:43], v20 offset:20992
ds_read_b64_tr_b16 v[44:45], v20 offset:28672
ds_read_b64_tr_b16 v[46:47], v20 offset:29184
s_waitcnt lgkmcnt(6)
v_mfma_f32_32x32x16_bf16 v[64:79], v[48:51], v[56:59], v[64:79]
v_mfma_f32_32x32x16_bf16 v[96:111], v[48:51], v[60:63], v[96:111]
v_mfma_f32_32x32x16_bf16 v[80:95], v[52:55], v[56:59], v[80:95]
v_mfma_f32_32x32x16_bf16 v[112:127], v[52:55], v[60:63], v[112:127]
ds_read_b128 v[48:51], v24 offset:0
ds_read_b128 v[52:55], v24 offset:4096
ds_read_b64_tr_b16 v[56:57], v20 offset:22528
ds_read_b64_tr_b16 v[58:59], v20 offset:23040
ds_read_b64_tr_b16 v[60:61], v20 offset:30720
ds_read_b64_tr_b16 v[62:63], v20 offset:31232
s_waitcnt lgkmcnt(6)
v_mfma_f32_32x32x16_bf16 v[64:79], v[32:35], v[40:43], v[64:79]
v_mfma_f32_32x32x16_bf16 v[96:111], v[32:35], v[44:47], v[96:111]
v_mfma_f32_32x32x16_bf16 v[80:95], v[36:39], v[40:43], v[80:95]
v_mfma_f32_32x32x16_bf16 v[112:127], v[36:39], v[44:47], v[112:127]
s_waitcnt lgkmcnt(0)
v_add_u32 v21, 81920, v16
v_add_u32 v22, 81920, v17
v_add_u32 v23, 81920, v18
v_add_u32 v24, 81920, v19
s_barrier
ds_read_b128 v[32:35], v21 offset:0
ds_read_b128 v[36:39], v21 offset:4096
ds_read_b64_tr_b16 v[40:41], v20 offset:32768
ds_read_b64_tr_b16 v[42:43], v20 offset:33280
ds_read_b64_tr_b16 v[44:45], v20 offset:40960
ds_read_b64_tr_b16 v[46:47], v20 offset:41472
v_mfma_f32_32x32x16_bf16 v[64:79], v[48:51], v[56:59], v[64:79]
v_mfma_f32_32x32x16_bf16 v[96:111], v[48:51], v[60:63], v[96:111]
v_mfma_f32_32x32x16_bf16 v[80:95], v[52:55], v[56:59], v[80:95]
v_mfma_f32_32x32x16_bf16 v[112:127], v[52:55], v[60:63], v[112:127]
ds_read_b128 v[48:51], v22 offset:0
ds_read_b128 v[52:55], v22 offset:4096
ds_read_b64_tr_b16 v[56:57], v20 offset:34816
ds_read_b64_tr_b16 v[58:59], v20 offset:35328
ds_read_b64_tr_b16 v[60:61], v20 offset:43008
ds_read_b64_tr_b16 v[62:63], v20 offset:43520
s_waitcnt lgkmcnt(6)
v_mfma_f32_32x32x16_bf16 v[64:79], v[32:35], v[40:43], v[64:79]
v_mfma_f32_32x32x16_bf16 v[96:111], v[32:35], v[44:47], v[96:111]
v_mfma_f32_32x32x16_bf16 v[80:95], v[36:39], v[40:43], v[80:95]
v_mfma_f32_32x32x16_bf16 v[112:127], v[36:39], v[44:47], v[112:127]
ds_read_b128 v[32:35], v23 offset:0
ds_read_b128 v[36:39], v23 offset:4096
ds_read_b64_tr_b16 v[40:41], v20 offset:36864
ds_read_b64_tr_b16 v[42:43], v20 offset:37376
ds_read_b64_tr_b16 v[44:45], v20 offset:45056
ds_read_b64_tr_b16 v[46:47], v20 offset:45568
s_waitcnt lgkmcnt(6)
v_mfma_f32_32x32x16_bf16 v[64:79], v[48:51], v[56:59], v[64:79]
v_mfma_f32_32x32x16_bf16 v[96:111], v[48:51], v[60:63], v[96:111]
v_mfma_f32_32x32x16_bf16 v[80:95], v[52:55], v[56:59], v[80:95]
v_mfma_f32_32x32x16_bf16 v[112:127], v[52:55], v[60:63], v[112:127]
ds_read_b128 v[48:51], v24 offset:0
ds_read_b128 v[52:55], v24 offset:4096
ds_read_b64_tr_b16 v[56:57], v20 offset:38912
ds_read_b64_tr_b16 v[58:59], v20 offset:39424
ds_read_b64_tr_b16 v[60:61], v20 offset:47104
ds_read_b64_tr_b16 v[62:63], v20 offset:47616
s_waitcnt lgkmcnt(6)
v_mfma_f32_32x32x16_bf16 v[64:79], v[32:35], v[40:43], v[64:79]
v_mfma_f32_32x32x16_bf16 v[96:111], v[32:35], v[44:47], v[96:111]
v_mfma_f32_32x32x16_bf16 v[80:95], v[36:39], v[40:43], v[80:95]
v_mfma_f32_32x32x16_bf16 v[112:127], v[36:39], v[44:47], v[112:127]
s_waitcnt lgkmcnt(0)
v_add_u32 v21, 98304, v16
v_add_u32 v22, 98304, v17
v_add_u32 v23, 98304, v18
v_add_u32 v24, 98304, v19
s_barrier
ds_read_b128 v[32:35], v21 offset:0
ds_read_b128 v[36:39], v21 offset:4096
ds_read_b64_tr_b16 v[40:41], v20 offset:0
ds_read_b64_tr_b16 v[42:43], v20 offset:512
ds_read_b64_tr_b16 v[44:45], v20 offset:8192
ds_read_b64_tr_b16 v[46:47], v20 offset:8704
v_mfma_f32_32x32x16_bf16 v[64:79], v[48:51], v[56:59], v[64:79]
v_mfma_f32_32x32x16_bf16 v[96:111], v[48:51], v[60:63], v[96:111]
v_mfma_f32_32x32x16_bf16 v[80:95], v[52:55], v[56:59], v[80:95]
v_mfma_f32_32x32x16_bf16 v[112:127], v[52:55], v[60:63], v[112:127]
ds_read_b128 v[48:51], v22 offset:0
ds_read_b128 v[52:55], v22 offset:4096
ds_read_b64_tr_b16 v[56:57], v20 offset:2048
ds_read_b64_tr_b16 v[58:59], v20 offset:2560
ds_read_b64_tr_b16 v[60:61], v20 offset:10240
ds_read_b64_tr_b16 v[62:63], v20 offset:10752
s_waitcnt lgkmcnt(6)
v_mfma_f32_32x32x16_bf16 v[64:79], v[32:35], v[40:43], v[64:79]
v_mfma_f32_32x32x16_bf16 v[96:111], v[32:35], v[44:47], v[96:111]
v_mfma_f32_32x32x16_bf16 v[80:95], v[36:39], v[40:43], v[80:95]
v_mfma_f32_32x32x16_bf16 v[112:127], v[36:39], v[44:47], v[112:127]
ds_read_b128 v[32:35], v23 offset:0
ds_read_b128 v[36:39], v23 offset:4096
ds_read_b64_tr_b16 v[40:41], v20 offset:4096
ds_read_b64_tr_b16 v[42:43], v20 offset:4608
ds_read_b64_tr_b16 v[44:45], v20 offset:12288
ds_read_b64_tr_b16 v[46:47], v20 offset:12800
s_waitcnt lgkmcnt(6)
v_mfma_f32_32x32x16_bf16 v[64:79], v[48:51], v[56:59], v[64:79]
v_mfma_f32_32x32x16_bf16 v[96:111], v[48:51], v[60:63], v[96:111]
v_mfma_f32_32x32x16_bf16 v[80:95], v[52:55], v[56:59], v[80:95]
v_mfma_f32_32x32x16_bf16 v[112:127], v[52:55], v[60:63], v[112:127]
ds_read_b128 v[48:51], v24 offset:0
ds_read_b128 v[52:55], v24 offset:4096
ds_read_b64_tr_b16 v[56:57], v20 offset:6144
ds_read_b64_tr_b16 v[58:59], v20 offset:6656
ds_read_b64_tr_b16 v[60:61], v20 offset:14336
ds_read_b64_tr_b16 v[62:63], v20 offset:14848
s_waitcnt lgkmcnt(6)
v_mfma_f32_32x32x16_bf16 v[64:79], v[32:35], v[40:43], v[64:79]
v_mfma_f32_32x32x16_bf16 v[96:111], v[32:35], v[44:47], v[96:111]
v_mfma_f32_32x32x16_bf16 v[80:95], v[36:39], v[40:43], v[80:95]
v_mfma_f32_32x32x16_bf16 v[112:127], v[36:39], v[44:47], v[112:127]
s_waitcnt lgkmcnt(0)
s_barrier
v_mfma_f32_32x32x16_bf16 v[64:79], v[48:51], v[56:59], v[64:79]
v_mfma_f32_32x32x16_bf16 v[96:111], v[48:51], v[60:63], v[96:111]
v_mfma_f32_32x32x16_bf16 v[80:95], v[52:55], v[56:59], v[80:95]
v_mfma_f32_32x32x16_bf16 v[112:127], v[52:55], v[60:63], v[112:127]
s_nop 9
v_cvt_pk_bf16_f32 v96, v96, v97
v_cndmask_b32 v96, v96, v12, s[54:55]
v_cvt_pk_bf16_f32 v97, v98, v99
v_cndmask_b32 v97, v97, v12, s[54:55]
v_cvt_pk_bf16_f32 v98, v100, v101
v_cndmask_b32 v98, v98, v12, s[54:55]
v_cvt_pk_bf16_f32 v99, v102, v103
v_cndmask_b32 v99, v99, v12, s[54:55]
v_cvt_pk_bf16_f32 v100, v104, v105
v_cndmask_b32 v100, v100, v12, s[54:55]
v_cvt_pk_bf16_f32 v101, v106, v107
v_cndmask_b32 v101, v101, v12, s[54:55]
v_cvt_pk_bf16_f32 v102, v108, v109
v_cndmask_b32 v102, v102, v12, s[54:55]
v_cvt_pk_bf16_f32 v103, v110, v111
v_cndmask_b32 v103, v103, v12, s[54:55]
v_pk_mul_f32 v[144:145], v[64:65], s[50:51]
v_exp_f32_e64 v144, v144 clamp
v_exp_f32_e64 v145, v145 clamp
v_max_f32 v64, s52, v64
v_max_f32 v65, s52, v65
v_pk_mul_f32 v[146:147], v[66:67], s[50:51]
v_pk_add_f32 v[144:145], v[144:145], v[64:65]
v_cvt_pk_bf16_f32 v64, v144, v145
v_exp_f32_e64 v146, v146 clamp
v_exp_f32_e64 v147, v147 clamp
v_max_f32 v66, s52, v66
v_max_f32 v67, s52, v67
v_pk_mul_f32 v[144:145], v[68:69], s[50:51]
v_pk_add_f32 v[146:147], v[146:147], v[66:67]
v_cvt_pk_bf16_f32 v65, v146, v147
v_exp_f32_e64 v144, v144 clamp
v_exp_f32_e64 v145, v145 clamp
v_max_f32 v68, s52, v68
v_max_f32 v69, s52, v69
v_pk_mul_f32 v[146:147], v[70:71], s[50:51]
v_pk_add_f32 v[144:145], v[144:145], v[68:69]
v_cvt_pk_bf16_f32 v66, v144, v145
v_exp_f32_e64 v146, v146 clamp
v_exp_f32_e64 v147, v147 clamp
v_max_f32 v70, s52, v70
v_max_f32 v71, s52, v71
v_pk_mul_f32 v[144:145], v[72:73], s[50:51]
v_pk_add_f32 v[146:147], v[146:147], v[70:71]
v_cvt_pk_bf16_f32 v67, v146, v147
v_exp_f32_e64 v144, v144 clamp
v_exp_f32_e64 v145, v145 clamp
v_max_f32 v72, s52, v72
v_max_f32 v73, s52, v73
v_pk_mul_f32 v[146:147], v[74:75], s[50:51]
v_pk_add_f32 v[144:145], v[144:145], v[72:73]
v_cvt_pk_bf16_f32 v68, v144, v145
v_exp_f32_e64 v146, v146 clamp
v_exp_f32_e64 v147, v147 clamp
v_max_f32 v74, s52, v74
v_max_f32 v75, s52, v75
v_pk_mul_f32 v[144:145], v[76:77], s[50:51]
v_pk_add_f32 v[146:147], v[146:147], v[74:75]
v_cvt_pk_bf16_f32 v69, v146, v147
v_exp_f32_e64 v144, v144 clamp
v_exp_f32_e64 v145, v145 clamp
v_max_f32 v76, s52, v76
v_max_f32 v77, s52, v77
v_pk_mul_f32 v[146:147], v[78:79], s[50:51]
v_pk_add_f32 v[144:145], v[144:145], v[76:77]
v_cvt_pk_bf16_f32 v70, v144, v145
v_exp_f32_e64 v146, v146 clamp
v_exp_f32_e64 v147, v147 clamp
v_max_f32 v78, s52, v78
v_max_f32 v79, s52, v79
v_pk_add_f32 v[146:147], v[146:147], v[78:79]
v_cvt_pk_bf16_f32 v71, v146, v147
v_mfma_f32_32x32x16_bf16 v[128:143], v[64:67], v[96:99], 0
s_nop 0
v_mfma_f32_32x32x16_bf16 v[128:143], v[68:71], v[100:103], v[128:143]
v_cvt_pk_bf16_f32 v112, v112, v113
v_cndmask_b32 v112, v112, v12, s[54:55]
v_cvt_pk_bf16_f32 v113, v114, v115
v_cndmask_b32 v113, v113, v12, s[54:55]
v_cvt_pk_bf16_f32 v114, v116, v117
v_cndmask_b32 v114, v114, v12, s[54:55]
v_cvt_pk_bf16_f32 v115, v118, v119
v_cndmask_b32 v115, v115, v12, s[54:55]
v_cvt_pk_bf16_f32 v116, v120, v121
v_cndmask_b32 v116, v116, v12, s[54:55]
v_cvt_pk_bf16_f32 v117, v122, v123
v_cndmask_b32 v117, v117, v12, s[54:55]
v_cvt_pk_bf16_f32 v118, v124, v125
v_cndmask_b32 v118, v118, v12, s[54:55]
v_cvt_pk_bf16_f32 v119, v126, v127
v_cndmask_b32 v119, v119, v12, s[54:55]
v_pk_mul_f32 v[144:145], v[80:81], s[50:51]
v_exp_f32_e64 v144, v144 clamp
v_exp_f32_e64 v145, v145 clamp
v_max_f32 v80, s52, v80
v_max_f32 v81, s52, v81
v_pk_mul_f32 v[146:147], v[82:83], s[50:51]
v_pk_add_f32 v[144:145], v[144:145], v[80:81]
v_cvt_pk_bf16_f32 v80, v144, v145
v_exp_f32_e64 v146, v146 clamp
v_exp_f32_e64 v147, v147 clamp
v_max_f32 v82, s52, v82
v_max_f32 v83, s52, v83
v_pk_mul_f32 v[144:145], v[84:85], s[50:51]
v_pk_add_f32 v[146:147], v[146:147], v[82:83]
v_cvt_pk_bf16_f32 v81, v146, v147
v_exp_f32_e64 v144, v144 clamp
v_exp_f32_e64 v145, v145 clamp
v_max_f32 v84, s52, v84
v_max_f32 v85, s52, v85
v_pk_mul_f32 v[146:147], v[86:87], s[50:51]
v_pk_add_f32 v[144:145], v[144:145], v[84:85]
v_cvt_pk_bf16_f32 v82, v144, v145
v_exp_f32_e64 v146, v146 clamp
v_exp_f32_e64 v147, v147 clamp
v_max_f32 v86, s52, v86
v_max_f32 v87, s52, v87
v_pk_mul_f32 v[144:145], v[88:89], s[50:51]
v_pk_add_f32 v[146:147], v[146:147], v[86:87]
v_cvt_pk_bf16_f32 v83, v146, v147
v_exp_f32_e64 v144, v144 clamp
v_exp_f32_e64 v145, v145 clamp
v_max_f32 v88, s52, v88
v_max_f32 v89, s52, v89
v_pk_mul_f32 v[146:147], v[90:91], s[50:51]
v_pk_add_f32 v[144:145], v[144:145], v[88:89]
v_cvt_pk_bf16_f32 v84, v144, v145
v_exp_f32_e64 v146, v146 clamp
v_exp_f32_e64 v147, v147 clamp
v_max_f32 v90, s52, v90
v_max_f32 v91, s52, v91
v_pk_mul_f32 v[144:145], v[92:93], s[50:51]
v_pk_add_f32 v[146:147], v[146:147], v[90:91]
v_cvt_pk_bf16_f32 v85, v146, v147
v_exp_f32_e64 v144, v144 clamp
v_exp_f32_e64 v145, v145 clamp
v_max_f32 v92, s52, v92
v_max_f32 v93, s52, v93
v_pk_mul_f32 v[146:147], v[94:95], s[50:51]
v_pk_add_f32 v[144:145], v[144:145], v[92:93]
v_cvt_pk_bf16_f32 v86, v144, v145
v_exp_f32_e64 v146, v146 clamp
v_exp_f32_e64 v147, v147 clamp
v_max_f32 v94, s52, v94
v_max_f32 v95, s52, v95
v_pk_add_f32 v[146:147], v[146:147], v[94:95]
v_cvt_pk_bf16_f32 v87, v146, v147
v_mfma_f32_32x32x16_bf16 v[128:143], v[80:83], v[112:115], v[128:143]
s_nop 0
v_mfma_f32_32x32x16_bf16 v[128:143], v[84:87], v[116:119], v[128:143]
s_and_b32 s3, s6, 1
s_lshl_b32 s3, s3, 12
s_add_u32 s3, s3, 114688
v_lshlrev_b32 v7, 4, v0
v_add_u32 v7, s3, v7
s_lshr_b32 s7, s6, 1
s_cmp_eq_u32 s7, 0
s_cbranch_scc0 LB_r1
s_nop 3
ds_write_b128 v7, v[136:139] offset:2048
ds_write_b128 v7, v[140:143] offset:3072
s_waitcnt lgkmcnt(0)
s_barrier
ds_read_b128 v[144:147], v7 offset:0
ds_read_b128 v[148:151], v7 offset:1024
s_waitcnt lgkmcnt(0)
v_pk_add_f32 v[144:145], v[144:145], v[128:129]
v_pk_add_f32 v[146:147], v[146:147], v[130:131]
v_pk_add_f32 v[148:149], v[148:149], v[132:133]
v_pk_add_f32 v[150:151], v[150:151], v[134:135]
s_branch LB_r2
LB_r1:
ds_write_b128 v7, v[128:131] offset:0
ds_write_b128 v7, v[132:135] offset:1024
s_waitcnt lgkmcnt(0)
s_barrier
ds_read_b128 v[144:147], v7 offset:2048
ds_read_b128 v[148:151], v7 offset:3072
s_waitcnt lgkmcnt(0)
v_pk_add_f32 v[144:145], v[144:145], v[136:137]
v_pk_add_f32 v[146:147], v[146:147], v[138:139]
v_pk_add_f32 v[148:149], v[148:149], v[140:141]
v_pk_add_f32 v[150:151], v[150:151], v[142:143]
LB_r2:
s_lshl_b32 s3, s5, 1
s_and_b32 s7, s6, 1
s_add_u32 s3, s3, s7
s_lshl_b32 s3, s3, 12
s_lshr_b32 s7, s6, 1
s_lshl_b32 s7, s7, 11
s_add_u32 s3, s3, s7
s_add_u32 s53, s3, 0x20000
v_lshlrev_b32 v5, 2, v0
v_add_u32 v21, 0, v16
v_add_u32 v22, 0, v17
v_add_u32 v23, 0, v18
v_add_u32 v24, 0, v19
v_add_u32 v108, 16384, v16
v_add_u32 v109, 16384, v17
v_add_u32 v110, 16384, v18
v_add_u32 v111, 16384, v19
ds_read_b128 v[32:35], v21 offset:0
ds_read_b128 v[36:39], v21 offset:4096
ds_read_b64_tr_b16 v[40:41], v20 offset:16384
ds_read_b64_tr_b16 v[42:43], v20 offset:16896
ds_read_b128 v[48:51], v22 offset:0
ds_read_b128 v[52:55], v22 offset:4096
ds_read_b64_tr_b16 v[56:57], v20 offset:18432
ds_read_b64_tr_b16 v[58:59], v20 offset:18944
ds_read_b128 v[96:99], v23 offset:0
ds_read_b128 v[100:103], v23 offset:4096
ds_read_b64_tr_b16 v[104:105], v20 offset:20480
ds_read_b64_tr_b16 v[106:107], v20 offset:20992
s_waitcnt lgkmcnt(8)
v_mfma_f32_32x32x16_bf16 v[64:79], v[40:43], v[32:35], 0
v_mfma_f32_32x32x16_bf16 v[80:95], v[40:43], v[36:39], 0
ds_read_b128 v[32:35], v24 offset:0
ds_read_b128 v[36:39], v24 offset:4096
ds_read_b64_tr_b16 v[40:41], v20 offset:22528
ds_read_b64_tr_b16 v[42:43], v20 offset:23040
v_add_u32 v21, 32768, v16
v_add_u32 v22, 32768, v17
v_add_u32 v23, 32768, v18
v_add_u32 v24, 32768, v19
s_waitcnt lgkmcnt(8)
v_mfma_f32_32x32x16_bf16 v[64:79], v[56:59], v[48:51], v[64:79]
v_mfma_f32_32x32x16_bf16 v[80:95], v[56:59], v[52:55], v[80:95]
ds_read_b128 v[48:51], v108 offset:0
ds_read_b128 v[52:55], v108 offset:4096
ds_read_b64_tr_b16 v[56:57], v20 offset:24576
ds_read_b64_tr_b16 v[58:59], v20 offset:25088
s_waitcnt lgkmcnt(8)
v_mfma_f32_32x32x16_bf16 v[64:79], v[104:107], v[96:99], v[64:79]
v_mfma_f32_32x32x16_bf16 v[80:95], v[104:107], v[100:103], v[80:95]
ds_read_b128 v[96:99], v109 offset:0
ds_read_b128 v[100:103], v109 offset:4096
ds_read_b64_tr_b16 v[104:105], v20 offset:26624
ds_read_b64_tr_b16 v[106:107], v20 offset:27136
s_waitcnt lgkmcnt(8)
v_mfma_f32_32x32x16_bf16 v[64:79], v[40:43], v[32:35], v[64:79]
v_mfma_f32_32x32x16_bf16 v[80:95], v[40:43], v[36:39], v[80:95]
ds_read_b128 v[32:35], v110 offset:0
ds_read_b128 v[36:39], v110 offset:4096
ds_read_b64_tr_b16 v[40:41], v20 offset:28672
ds_read_b64_tr_b16 v[42:43], v20 offset:29184
s_waitcnt lgkmcnt(8)
v_mfma_f32_32x32x16_bf16 v[64:79], v[56:59], v[48:51], v[64:79]
v_mfma_f32_32x32x16_bf16 v[80:95], v[56:59], v[52:55], v[80:95]
ds_read_b128 v[48:51], v111 offset:0
ds_read_b128 v[52:55], v111 offset:4096
ds_read_b64_tr_b16 v[56:57], v20 offset:30720
ds_read_b64_tr_b16 v[58:59], v20 offset:31232
v_add_u32 v108, 49152, v16
v_add_u32 v109, 49152, v17
v_add_u32 v110, 49152, v18
v_add_u32 v111, 49152, v19
s_waitcnt lgkmcnt(8)
v_mfma_f32_32x32x16_bf16 v[64:79], v[104:107], v[96:99], v[64:79]
v_mfma_f32_32x32x16_bf16 v[80:95], v[104:107], v[100:103], v[80:95]
s_waitcnt lgkmcnt(0)
s_barrier
ds_read_b128 v[96:99], v21 offset:0
ds_read_b128 v[100:103], v21 offset:4096
ds_read_b64_tr_b16 v[104:105], v20 offset:32768
ds_read_b64_tr_b16 v[106:107], v20 offset:33280
s_waitcnt lgkmcnt(8)
v_mfma_f32_32x32x16_bf16 v[64:79], v[40:43], v[32:35], v[64:79]
v_mfma_f32_32x32x16_bf16 v[80:95], v[40:43], v[36:39], v[80:95]
ds_read_b128 v[32:35], v22 offset:0
ds_read_b128 v[36:39], v22 offset:4096
ds_read_b64_tr_b16 v[40:41], v20 offset:34816
ds_read_b64_tr_b16 v[42:43], v20 offset:35328
s_waitcnt lgkmcnt(8)
v_mfma_f32_32x32x16_bf16 v[64:79], v[56:59], v[48:51], v[64:79]
v_mfma_f32_32x32x16_bf16 v[80:95], v[56:59], v[52:55], v[80:95]
buffer_atomic_add_f32 v144, v5, s[16:19], s53 offen offset:0
ds_read_b128 v[48:51], v23 offset:0
ds_read_b128 v[52:55], v23 offset:4096
ds_read_b64_tr_b16 v[56:57], v20 offset:36864
ds_read_b64_tr_b16 v[58:59], v20 offset:37376
s_waitcnt lgkmcnt(8)
v_mfma_f32_32x32x16_bf16 v[64:79], v[104:107], v[96:99], v[64:79]
v_mfma_f32_32x32x16_bf16 v[80:95], v[104:107], v[100:103], v[80:95]
buffer_atomic_add_f32 v145, v5, s[16:19], s53 offen offset:256
ds_read_b128 v[96:99], v24 offset:0
ds_read_b128 v[100:103], v24 offset:4096
ds_read_b64_tr_b16 v[104:105], v20 offset:38912
ds_read_b64_tr_b16 v[106:107], v20 offset:39424
v_add_u32 v21, 65536, v16
v_add_u32 v22, 65536, v17
v_add_u32 v23, 65536, v18
v_add_u32 v24, 65536, v19
s_waitcnt lgkmcnt(8)
v_mfma_f32_32x32x16_bf16 v[64:79], v[40:43], v[32:35], v[64:79]
v_mfma_f32_32x32x16_bf16 v[80:95], v[40:43], v[36:39], v[80:95]
buffer_atomic_add_f32 v146, v5, s[16:19], s53 offen offset:512
ds_read_b128 v[32:35], v108 offset:0
ds_read_b128 v[36:39], v108 offset:4096
ds_read_b64_tr_b16 v[40:41], v20 offset:40960
ds_read_b64_tr_b16 v[42:43], v20 offset:41472
s_waitcnt lgkmcnt(8)
v_mfma_f32_32x32x16_bf16 v[64:79], v[56:59], v[48:51], v[64:79]
v_mfma_f32_32x32x16_bf16 v[80:95], v[56:59], v[52:55], v[80:95]
buffer_atomic_add_f32 v147, v5, s[16:19], s53 offen offset:768
ds_read_b128 v[48:51], v109 offset:0
ds_read_b128 v[52:55], v109 offset:4096
ds_read_b64_tr_b16 v[56:57], v20 offset:43008
ds_read_b64_tr_b16 v[58:59], v20 offset:43520
s_waitcnt lgkmcnt(8)
v_mfma_f32_32x32x16_bf16 v[64:79], v[104:107], v[96:99], v[64:79]
v_mfma_f32_32x32x16_bf16 v[80:95], v[104:107], v[100:103], v[80:95]
buffer_atomic_add_f32 v148, v5, s[16:19], s53 offen offset:1024
ds_read_b128 v[96:99], v110 offset:0
ds_read_b128 v[100:103], v110 offset:4096
ds_read_b64_tr_b16 v[104:105], v20 offset:45056
ds_read_b64_tr_b16 v[106:107], v20 offset:45568
s_waitcnt lgkmcnt(8)
v_mfma_f32_32x32x16_bf16 v[64:79], v[40:43], v[32:35], v[64:79]
v_mfma_f32_32x32x16_bf16 v[80:95], v[40:43], v[36:39], v[80:95]
buffer_atomic_add_f32 v149, v5, s[16:19], s53 offen offset:1280
ds_read_b128 v[32:35], v111 offset:0
ds_read_b128 v[36:39], v111 offset:4096
ds_read_b64_tr_b16 v[40:41], v20 offset:47104
ds_read_b64_tr_b16 v[42:43], v20 offset:47616
v_add_u32 v108, 81920, v16
v_add_u32 v109, 81920, v17
v_add_u32 v110, 81920, v18
v_add_u32 v111, 81920, v19
s_waitcnt lgkmcnt(8)
v_mfma_f32_32x32x16_bf16 v[64:79], v[56:59], v[48:51], v[64:79]
v_mfma_f32_32x32x16_bf16 v[80:95], v[56:59], v[52:55], v[80:95]
buffer_atomic_add_f32 v150, v5, s[16:19], s53 offen offset:1536
ds_read_b128 v[48:51], v21 offset:0
ds_read_b128 v[52:55], v21 offset:4096
ds_read_b64_tr_b16 v[56:57], v20 offset:8192
ds_read_b64_tr_b16 v[58:59], v20 offset:8704
s_waitcnt lgkmcnt(8)
v_mfma_f32_32x32x16_bf16 v[64:79], v[104:107], v[96:99], v[64:79]
v_mfma_f32_32x32x16_bf16 v[80:95], v[104:107], v[100:103], v[80:95]
buffer_atomic_add_f32 v151, v5, s[16:19], s53 offen offset:1792
ds_read_b128 v[96:99], v22 offset:0
ds_read_b128 v[100:103], v22 offset:4096
ds_read_b64_tr_b16 v[104:105], v20 offset:10240
ds_read_b64_tr_b16 v[106:107], v20 offset:10752
s_waitcnt lgkmcnt(8)
v_mfma_f32_32x32x16_bf16 v[64:79], v[40:43], v[32:35], v[64:79]
v_mfma_f32_32x32x16_bf16 v[80:95], v[40:43], v[36:39], v[80:95]
ds_read_b128 v[32:35], v23 offset:0
ds_read_b128 v[36:39], v23 offset:4096
ds_read_b64_tr_b16 v[40:41], v20 offset:12288
ds_read_b64_tr_b16 v[42:43], v20 offset:12800
s_waitcnt lgkmcnt(8)
v_mfma_f32_32x32x16_bf16 v[64:79], v[56:59], v[48:51], v[64:79]
v_mfma_f32_32x32x16_bf16 v[80:95], v[56:59], v[52:55], v[80:95]
ds_read_b128 v[48:51], v24 offset:0
ds_read_b128 v[52:55], v24 offset:4096
ds_read_b64_tr_b16 v[56:57], v20 offset:14336
ds_read_b64_tr_b16 v[58:59], v20 offset:14848
v_add_u32 v21, 98304, v16
v_add_u32 v22, 98304, v17
v_add_u32 v23, 98304, v18
v_add_u32 v24, 98304, v19
s_waitcnt lgkmcnt(8)
v_mfma_f32_32x32x16_bf16 v[64:79], v[104:107], v[96:99], v[64:79]
v_mfma_f32_32x32x16_bf16 v[80:95], v[104:107], v[100:103], v[80:95]
s_waitcnt lgkmcnt(0)
s_barrier
ds_read_b128 v[96:99], v108 offset:0
ds_read_b128 v[100:103], v108 offset:4096
ds_read_b64_tr_b16 v[104:105], v20 offset:16384
ds_read_b64_tr_b16 v[106:107], v20 offset:16896
s_waitcnt lgkmcnt(8)
v_mfma_f32_32x32x16_bf16 v[64:79], v[40:43], v[32:35], v[64:79]
v_mfma_f32_32x32x16_bf16 v[80:95], v[40:43], v[36:39], v[80:95]
ds_read_b128 v[32:35], v109 offset:0
ds_read_b128 v[36:39], v109 offset:4096
ds_read_b64_tr_b16 v[40:41], v20 offset:18432
ds_read_b64_tr_b16 v[42:43], v20 offset:18944
s_waitcnt lgkmcnt(8)
v_mfma_f32_32x32x16_bf16 v[64:79], v[56:59], v[48:51], v[64:79]
v_mfma_f32_32x32x16_bf16 v[80:95], v[56:59], v[52:55], v[80:95]
ds_read_b128 v[48:51], v110 offset:0
ds_read_b128 v[52:55], v110 offset:4096
ds_read_b64_tr_b16 v[56:57], v20 offset:20480
ds_read_b64_tr_b16 v[58:59], v20 offset:20992
s_waitcnt lgkmcnt(8)
v_mfma_f32_32x32x16_bf16 v[64:79], v[104:107], v[96:99], v[64:79]
v_mfma_f32_32x32x16_bf16 v[80:95], v[104:107], v[100:103], v[80:95]
ds_read_b128 v[96:99], v111 offset:0
ds_read_b128 v[100:103], v111 offset:4096
ds_read_b64_tr_b16 v[104:105], v20 offset:22528
ds_read_b64_tr_b16 v[106:107], v20 offset:23040
s_waitcnt lgkmcnt(8)
v_mfma_f32_32x32x16_bf16 v[64:79], v[40:43], v[32:35], v[64:79]
v_mfma_f32_32x32x16_bf16 v[80:95], v[40:43], v[36:39], v[80:95]
ds_read_b128 v[32:35], v21 offset:0
ds_read_b128 v[36:39], v21 offset:4096
ds_read_b64_tr_b16 v[40:41], v20 offset:24576
ds_read_b64_tr_b16 v[42:43], v20 offset:25088
s_waitcnt lgkmcnt(8)
v_mfma_f32_32x32x16_bf16 v[64:79], v[56:59], v[48:51], v[64:79]
v_mfma_f32_32x32x16_bf16 v[80:95], v[56:59], v[52:55], v[80:95]
ds_read_b128 v[48:51], v22 offset:0
ds_read_b128 v[52:55], v22 offset:4096
ds_read_b64_tr_b16 v[56:57], v20 offset:26624
ds_read_b64_tr_b16 v[58:59], v20 offset:27136
s_waitcnt lgkmcnt(8)
v_mfma_f32_32x32x16_bf16 v[64:79], v[104:107], v[96:99], v[64:79]
v_mfma_f32_32x32x16_bf16 v[80:95], v[104:107], v[100:103], v[80:95]
ds_read_b128 v[96:99], v23 offset:0
ds_read_b128 v[100:103], v23 offset:4096
ds_read_b64_tr_b16 v[104:105], v20 offset:28672
ds_read_b64_tr_b16 v[106:107], v20 offset:29184
s_waitcnt lgkmcnt(8)
v_mfma_f32_32x32x16_bf16 v[64:79], v[40:43], v[32:35], v[64:79]
v_mfma_f32_32x32x16_bf16 v[80:95], v[40:43], v[36:39], v[80:95]
ds_read_b128 v[32:35], v24 offset:0
ds_read_b128 v[36:39], v24 offset:4096
ds_read_b64_tr_b16 v[40:41], v20 offset:30720
ds_read_b64_tr_b16 v[42:43], v20 offset:31232
s_waitcnt lgkmcnt(8)
v_mfma_f32_32x32x16_bf16 v[64:79], v[56:59], v[48:51], v[64:79]
v_mfma_f32_32x32x16_bf16 v[80:95], v[56:59], v[52:55], v[80:95]
s_waitcnt lgkmcnt(4)
v_mfma_f32_32x32x16_bf16 v[64:79], v[104:107], v[96:99], v[64:79]
v_mfma_f32_32x32x16_bf16 v[80:95], v[104:107], v[100:103], v[80:95]
s_waitcnt vmcnt(0) lgkmcnt(0)
s_barrier
s_cmp_eq_u32 s6, 0
s_cbranch_scc0 LB_nofk
s_lshl_b32 s3, s4, 3
s_add_u32 s3, s3, s5
s_lshl_b32 s3, s3, 7
s_add_u32 s45, s3, 0x10000
v_mov_b32 v8, 0
v_mov_b32 v9, 1
s_mov_b64 exec, 1
buffer_store_dword v9, v8, s[16:19], s45 offen sc1
s_mov_b64 exec, -1
LB_nofk:
v_mfma_f32_32x32x16_bf16 v[64:79], v[40:43], v[32:35], v[64:79]
v_mfma_f32_32x32x16_bf16 v[80:95], v[40:43], v[36:39], v[80:95]
s_lshr_b32 s7, s6, 1
s_lshl_b32 s7, s7, 1
s_lshl_b32 s3, s4, 2
s_add_u32 s3, s3, s7
s_lshl_b32 s3, s3, 4
s_lshl_b32 s7, s5, 1
s_add_u32 s3, s3, s7
s_and_b32 s7, s6, 1
s_add_u32 s3, s3, s7
s_lshl_b32 s3, s3, 11
s_add_u32 s44, s3, 0x200000
v_lshlrev_b32 v5, 4, v0
v_mov_b32 v6, 0
v_pk_mul_f32 v[144:145], v[64:65], s[50:51]
v_exp_f32_e64 v144, v144 clamp
v_exp_f32_e64 v145, v145 clamp
v_max_f32 v64, s52, v64
v_max_f32 v65, s52, v65
v_pk_mul_f32 v[146:147], v[66:67], s[50:51]
v_pk_add_f32 v[144:145], v[144:145], v[64:65]
v_cvt_pk_bf16_f32 v64, v144, v145
v_exp_f32_e64 v146, v146 clamp
v_exp_f32_e64 v147, v147 clamp
v_max_f32 v66, s52, v66
v_max_f32 v67, s52, v67
v_pk_mul_f32 v[144:145], v[68:69], s[50:51]
v_pk_add_f32 v[146:147], v[146:147], v[66:67]
v_cvt_pk_bf16_f32 v65, v146, v147
v_exp_f32_e64 v144, v144 clamp
v_exp_f32_e64 v145, v145 clamp
v_max_f32 v68, s52, v68
v_max_f32 v69, s52, v69
v_pk_mul_f32 v[146:147], v[70:71], s[50:51]
v_pk_add_f32 v[144:145], v[144:145], v[68:69]
v_cvt_pk_bf16_f32 v66, v144, v145
v_exp_f32_e64 v146, v146 clamp
v_exp_f32_e64 v147, v147 clamp
v_max_f32 v70, s52, v70
v_max_f32 v71, s52, v71
v_pk_mul_f32 v[144:145], v[72:73], s[50:51]
v_pk_add_f32 v[146:147], v[146:147], v[70:71]
v_cvt_pk_bf16_f32 v67, v146, v147
v_exp_f32_e64 v144, v144 clamp
v_exp_f32_e64 v145, v145 clamp
v_max_f32 v72, s52, v72
v_max_f32 v73, s52, v73
v_pk_mul_f32 v[146:147], v[74:75], s[50:51]
v_pk_add_f32 v[144:145], v[144:145], v[72:73]
v_cvt_pk_bf16_f32 v68, v144, v145
v_exp_f32_e64 v146, v146 clamp
v_exp_f32_e64 v147, v147 clamp
v_max_f32 v74, s52, v74
v_max_f32 v75, s52, v75
v_pk_mul_f32 v[144:145], v[76:77], s[50:51]
v_pk_add_f32 v[146:147], v[146:147], v[74:75]
v_cvt_pk_bf16_f32 v69, v146, v147
v_exp_f32_e64 v144, v144 clamp
v_exp_f32_e64 v145, v145 clamp
v_max_f32 v76, s52, v76
v_max_f32 v77, s52, v77
v_pk_mul_f32 v[146:147], v[78:79], s[50:51]
v_pk_add_f32 v[144:145], v[144:145], v[76:77]
v_cvt_pk_bf16_f32 v70, v144, v145
v_exp_f32_e64 v146, v146 clamp
v_exp_f32_e64 v147, v147 clamp
v_max_f32 v78, s52, v78
v_max_f32 v79, s52, v79
v_pk_add_f32 v[146:147], v[146:147], v[78:79]
v_cvt_pk_bf16_f32 v71, v146, v147
v_cndmask_b32 v70, v70, v6, s[56:57]
v_cndmask_b32 v71, v71, v6, s[56:57]
s_add_u32 s45, s44, 0
buffer_store_dwordx4 v[64:67], v5, s[16:19], s45 offen sc1
s_add_u32 s45, s44, 1024
buffer_store_dwordx4 v[68:71], v5, s[16:19], s45 offen sc1
v_pk_mul_f32 v[144:145], v[80:81], s[50:51]
v_exp_f32_e64 v144, v144 clamp
v_exp_f32_e64 v145, v145 clamp
v_max_f32 v80, s52, v80
v_max_f32 v81, s52, v81
v_pk_mul_f32 v[146:147], v[82:83], s[50:51]
v_pk_add_f32 v[144:145], v[144:145], v[80:81]
v_cvt_pk_bf16_f32 v80, v144, v145
v_exp_f32_e64 v146, v146 clamp
v_exp_f32_e64 v147, v147 clamp
v_max_f32 v82, s52, v82
v_max_f32 v83, s52, v83
v_pk_mul_f32 v[144:145], v[84:85], s[50:51]
v_pk_add_f32 v[146:147], v[146:147], v[82:83]
v_cvt_pk_bf16_f32 v81, v146, v147
v_exp_f32_e64 v144, v144 clamp
v_exp_f32_e64 v145, v145 clamp
v_max_f32 v84, s52, v84
v_max_f32 v85, s52, v85
v_pk_mul_f32 v[146:147], v[86:87], s[50:51]
v_pk_add_f32 v[144:145], v[144:145], v[84:85]
v_cvt_pk_bf16_f32 v82, v144, v145
v_exp_f32_e64 v146, v146 clamp
v_exp_f32_e64 v147, v147 clamp
v_max_f32 v86, s52, v86
v_max_f32 v87, s52, v87
v_pk_mul_f32 v[144:145], v[88:89], s[50:51]
v_pk_add_f32 v[146:147], v[146:147], v[86:87]
v_cvt_pk_bf16_f32 v83, v146, v147
v_exp_f32_e64 v144, v144 clamp
v_exp_f32_e64 v145, v145 clamp
v_max_f32 v88, s52, v88
v_max_f32 v89, s52, v89
v_pk_mul_f32 v[146:147], v[90:91], s[50:51]
v_pk_add_f32 v[144:145], v[144:145], v[88:89]
v_cvt_pk_bf16_f32 v84, v144, v145
v_exp_f32_e64 v146, v146 clamp
v_exp_f32_e64 v147, v147 clamp
v_max_f32 v90, s52, v90
v_max_f32 v91, s52, v91
v_pk_mul_f32 v[144:145], v[92:93], s[50:51]
v_pk_add_f32 v[146:147], v[146:147], v[90:91]
v_cvt_pk_bf16_f32 v85, v146, v147
v_exp_f32_e64 v144, v144 clamp
v_exp_f32_e64 v145, v145 clamp
v_max_f32 v92, s52, v92
v_max_f32 v93, s52, v93
v_pk_mul_f32 v[146:147], v[94:95], s[50:51]
v_pk_add_f32 v[144:145], v[144:145], v[92:93]
v_cvt_pk_bf16_f32 v86, v144, v145
v_exp_f32_e64 v146, v146 clamp
v_exp_f32_e64 v147, v147 clamp
v_max_f32 v94, s52, v94
v_max_f32 v95, s52, v95
v_pk_add_f32 v[146:147], v[146:147], v[94:95]
v_cvt_pk_bf16_f32 v87, v146, v147
v_cndmask_b32 v86, v86, v6, s[56:57]
v_cndmask_b32 v87, v87, v6, s[56:57]
s_add_u32 s45, s44, 32768
buffer_store_dwordx4 v[80:83], v5, s[16:19], s45 offen sc1
s_add_u32 s45, s44, 33792
buffer_store_dwordx4 v[84:87], v5, s[16:19], s45 offen sc1
s_mov_b32 s20, s88
s_mov_b32 s21, s89
s_mov_b32 s22, 0x700000
s_mov_b32 s23, 0x20000
v_lshrrev_b32 v4, 4, v0
v_and_b32 v6, 1, v4
v_lshrrev_b32 v4, 1, v4
v_and_b32 v7, 15, v0
v_lshrrev_b32 v7, 2, v7
v_and_b32 v8, 3, v0
v_lshlrev_b32 v4, 2, v4
v_add_u32 v4, v4, v7
v_lshlrev_b32 v6, 5, v6
v_lshlrev_b32 v8, 3, v8
v_add_u32 v6, v6, v8
s_lshr_b32 s7, s6, 2
s_lshl_b32 s3, s7, 14
s_add_u32 s3, s3, 65536
v_lshlrev_b32 v9, 6, v4
v_add_u32 v9, v9, v6
v_add_u32 v96, s3, v9
s_lshl_b32 s3, s7, 15
v_lshrrev_b32 v7, 1, v7
v_lshlrev_b32 v7, 6, v7
v_lshlrev_b32 v10, 7, v4
v_add_u32 v10, s3, v10
v_xor_b32 v11, v6, v7
v_add_u32 v97, v11, v10
v_add_u32 v11, 64, v6
v_xor_b32 v11, v11, v7
v_add_u32 v98, v11, v10
v_and_b32 v1, 31, v0
v_lshrrev_b32 v2, 5, v0
v_and_b32 v3, 7, v1
v_lshlrev_b32 v4, 7, v1
s_lshl_b32 s3, s6, 13
s_add_u32 s3, s3, 98304
v_add_u32 v4, s3, v4
v_add_u32 v6, 0, v2
v_xor_b32 v6, v6, v3
v_lshlrev_b32 v6, 4, v6
v_add_u32 v240, v6, v4
v_add_u32 v6, 2, v2
v_xor_b32 v6, v6, v3
v_lshlrev_b32 v6, 4, v6
v_add_u32 v241, v6, v4
v_add_u32 v6, 4, v2
v_xor_b32 v6, v6, v3
v_lshlrev_b32 v6, 4, v6
v_add_u32 v242, v6, v4
v_add_u32 v6, 6, v2
v_xor_b32 v6, v6, v3
v_lshlrev_b32 v6, 4, v6
v_add_u32 v243, v6, v4
v_lshlrev_b32 v6, 4, v0
s_lshr_b32 s7, s6, 2
s_lshl_b32 s7, s7, 12
s_lshl_b32 s3, s6, 13
s_add_u32 s3, s3, s7
s_add_u32 s3, s3, 98304
v_add_u32 v244, s3, v6
s_xor_b32 s3, s6, 4
s_lshl_b32 s3, s3, 13
s_add_u32 s3, s3, s7
s_add_u32 s3, s3, 98304
v_add_u32 v245, s3, v6
v_lshrrev_b32 v9, 3, v0
v_and_b32 v10, 7, v0
v_xor_b32 v10, v10, v9
v_lshlrev_b32 v10, 4, v10
v_mul_u32_u24 v9, 3584, v9
v_add_u32 v246, v9, v10
s_and_b32 s7, s6, 3
s_lshl_b32 s7, s7, 5
s_lshl_b32 s3, s4, 7
s_add_u32 s3, s3, s7
s_mul_i32 s3, s3, 3584
s_lshl_b32 s7, s5, 8
s_add_u32 s3, s3, s7
s_lshr_b32 s7, s6, 2
s_lshl_b32 s7, s7, 7
s_add_u32 s3, s3, s7
s_add_u32 s58, s3, 1792
v_mov_b32 v8, 163824
v_mov_b32 v9, 1
s_waitcnt vmcnt(0)
s_mov_b64 exec, 1
ds_add_rtn_u32 v10, v8, v9
s_waitcnt lgkmcnt(0)
v_readfirstlane_b32 s3, v10
s_cmp_eq_u32 s3, 3
s_cbranch_scc0 LB_nofl
s_lshl_b32 s3, s4, 3
s_add_u32 s3, s3, s5
s_lshl_b32 s3, s3, 7
s_add_u32 s45, s3, 0x1c000
v_mov_b32 v8, 0
buffer_store_dword v9, v8, s[16:19], s45 offen sc1
LB_nofl:
s_mov_b64 exec, -1
s_cmp_eq_u32 s5, 7
s_cbranch_scc1 LB_end
v_mov_b32 v10, 163808
s_cmp_eq_u32 s6, 0
s_cbranch_scc0 LB_pq_lds
s_lshl_b32 s3, s4, 10
s_add_u32 s45, s3, 0x1c000
v_lshlrev_b32 v8, 7, v0
s_mov_b64 exec, 0xff
s_mov_b32 s46, 0
LB_pq:
buffer_load_dword v9, v8, s[16:19], s45 offen sc1
s_waitcnt vmcnt(0)
v_cmp_ne_u32 vcc, 0, v9
s_cmp_eq_u64 vcc, exec
s_cbranch_scc1 LB_pq_ok
s_add_u32 s46, s46, 1
s_cmp_lt_u32 s46, 0x40000
s_cbranch_scc1 LB_pq
LB_pq_ok:
s_mov_b64 exec, 1
v_mov_b32 v9, 1
ds_write_b32 v10, v9
s_mov_b64 exec, -1
s_branch LB_pq_go
LB_pq_lds:
s_mov_b32 s46, 0
LB_c_lw:
ds_read_b32 v9, v10
s_waitcnt lgkmcnt(0)
v_readfirstlane_b32 s3, v9
s_cmp_lg_u32 s3, 0
s_cbranch_scc1 LB_c_lw_ok
s_sleep 1
s_add_u32 s46, s46, 1
s_cmp_lt_u32 s46, 0x400000
s_cbranch_scc1 LB_c_lw
LB_c_lw_ok:
LB_pq_go:
v_lshlrev_b32 v5, 4, v0
s_and_b32 s7, s6, 3
s_lshl_b32 s3, s4, 2
s_add_u32 s3, s3, s7
s_lshl_b32 s3, s3, 15
s_lshr_b32 s7, s6, 2
s_lshl_b32 s7, s7, 14
s_add_u32 s3, s3, s7
s_add_u32 s44, s3, 0x200000
s_add_u32 s45, s44, 0
buffer_load_dwordx4 v[128:131], v5, s[16:19], s45 offen sc1
s_add_u32 s45, s44, 1024
buffer_load_dwordx4 v[132:135], v5, s[16:19], s45 offen sc1
s_add_u32 s45, s44, 2048
buffer_load_dwordx4 v[136:139], v5, s[16:19], s45 offen sc1
s_add_u32 s45, s44, 3072
buffer_load_dwordx4 v[140:143], v5, s[16:19], s45 offen sc1
s_add_u32 s45, s44, 4096
buffer_load_dwordx4 v[144:147], v5, s[16:19], s45 offen sc1
s_add_u32 s45, s44, 5120
buffer_load_dwordx4 v[148:151], v5, s[16:19], s45 offen sc1
LB_b2:
s_barrier
ds_read_b64_tr_b16 v[48:49], v96 offset:0
ds_read_b64_tr_b16 v[50:51], v96 offset:512
ds_read_b64_tr_b16 v[52:53], v96 offset:1024
ds_read_b64_tr_b16 v[54:55], v96 offset:1536
ds_read_b64_tr_b16 v[56:57], v96 offset:2048
ds_read_b64_tr_b16 v[58:59], v96 offset:2560
ds_read_b64_tr_b16 v[60:61], v96 offset:3072
ds_read_b64_tr_b16 v[62:63], v96 offset:3584
s_waitcnt vmcnt(4) lgkmcnt(4)
v_mfma_f32_32x32x16_bf16 v[192:207], v[48:51], v[128:131], 0
v_mfma_f32_32x32x16_bf16 v[192:207], v[52:55], v[132:135], v[192:207]
s_waitcnt vmcnt(2) lgkmcnt(0)
v_mfma_f32_32x32x16_bf16 v[208:223], v[56:59], v[136:139], 0
s_nop 9
v_mov_b32 v14, v204
ds_read_b64_tr_b16 v[48:49], v96 offset:4096
ds_read_b64_tr_b16 v[50:51], v96 offset:4608
v_permlane32_swap_b32 v204, v14
v_add_f32 v14, s52, v14
v_rcp_f32 v14, v14
ds_read_b64_tr_b16 v[52:53], v96 offset:5120
s_add_u32 s45, s44, 6144
buffer_load_dwordx4 v[152:155], v5, s[16:19], s45 offen sc1
s_add_u32 s45, s44, 7168
buffer_load_dwordx4 v[156:159], v5, s[16:19], s45 offen sc1
v_mfma_f32_32x32x16_bf16 v[208:223], v[60:63], v[140:143], v[208:223]
ds_read_b64_tr_b16 v[54:55], v96 offset:5632
ds_read_b64_tr_b16 v[64:65], v97 offset:0
ds_read_b64_tr_b16 v[66:67], v97 offset:1024
ds_read_b64_tr_b16 v[68:69], v98 offset:0
ds_read_b64_tr_b16 v[70:71], v98 offset:1024
ds_read_b64_tr_b16 v[72:73], v97 offset:2048
ds_read_b64_tr_b16 v[74:75], v97 offset:3072
ds_read_b64_tr_b16 v[76:77], v98 offset:2048
ds_read_b64_tr_b16 v[78:79], v98 offset:3072
v_mul_f32 v192, v14, v192
v_mul_f32 v193, v14, v193
v_cvt_pk_bf16_f32 v224, v192, v193
v_mul_f32 v194, v14, v194
v_mul_f32 v195, v14, v195
v_cvt_pk_bf16_f32 v225, v194, v195
v_mul_f32 v196, v14, v196
v_mul_f32 v197, v14, v197
v_cvt_pk_bf16_f32 v226, v196, v197
v_mul_f32 v198, v14, v198
v_mul_f32 v199, v14, v199
v_cvt_pk_bf16_f32 v227, v198, v199
v_mul_f32 v200, v14, v200
v_mul_f32 v201, v14, v201
v_cvt_pk_bf16_f32 v228, v200, v201
v_mul_f32 v202, v14, v202
v_mul_f32 v203, v14, v203
v_cvt_pk_bf16_f32 v229, v202, v203
v_mul_f32 v204, v14, v204
v_mul_f32 v205, v14, v205
v_cvt_pk_bf16_f32 v230, v204, v205
v_mul_f32 v206, v14, v206
v_mul_f32 v207, v14, v207
v_cvt_pk_bf16_f32 v231, v206, v207
s_waitcnt vmcnt(2) lgkmcnt(0)
v_mfma_f32_32x32x16_bf16 v[192:207], v[48:51], v[144:147], 0
v_mov_b32 v14, v220
ds_read_b64_tr_b16 v[56:57], v96 offset:6144
ds_read_b64_tr_b16 v[58:59], v96 offset:6656
v_permlane32_swap_b32 v220, v14
v_add_f32 v14, s52, v14
v_rcp_f32 v14, v14
ds_read_b64_tr_b16 v[60:61], v96 offset:7168
s_add_u32 s45, s44, 8192
buffer_load_dwordx4 v[160:163], v5, s[16:19], s45 offen sc1
s_add_u32 s45, s44, 9216
buffer_load_dwordx4 v[164:167], v5, s[16:19], s45 offen sc1
v_mfma_f32_32x32x16_bf16 v[192:207], v[52:55], v[148:151], v[192:207]
ds_read_b64_tr_b16 v[62:63], v96 offset:7680
ds_read_b64_tr_b16 v[80:81], v97 offset:4096
ds_read_b64_tr_b16 v[82:83], v97 offset:5120
v_mul_f32 v208, v14, v208
v_mul_f32 v209, v14, v209
v_cvt_pk_bf16_f32 v232, v208, v209
v_mul_f32 v210, v14, v210
v_mul_f32 v211, v14, v211
v_mfma_f32_32x32x16_bf16 v[16:31], v[64:67], v[224:227], 0
ds_read_b64_tr_b16 v[84:85], v98 offset:4096
ds_read_b64_tr_b16 v[86:87], v98 offset:5120
ds_read_b64_tr_b16 v[88:89], v97 offset:6144
v_cvt_pk_bf16_f32 v233, v210, v211
v_mul_f32 v212, v14, v212
v_mul_f32 v213, v14, v213
v_cvt_pk_bf16_f32 v234, v212, v213
v_mul_f32 v214, v14, v214
v_mfma_f32_32x32x16_bf16 v[32:47], v[68:71], v[224:227], 0
ds_read_b64_tr_b16 v[90:91], v97 offset:7168
ds_read_b64_tr_b16 v[92:93], v98 offset:6144
ds_read_b64_tr_b16 v[94:95], v98 offset:7168
v_mul_f32 v215, v14, v215
v_cvt_pk_bf16_f32 v235, v214, v215
v_mul_f32 v216, v14, v216
v_mul_f32 v217, v14, v217
v_cvt_pk_bf16_f32 v236, v216, v217
v_mfma_f32_32x32x16_bf16 v[16:31], v[72:75], v[228:231], v[16:31]
v_mul_f32 v218, v14, v218
v_mul_f32 v219, v14, v219
v_cvt_pk_bf16_f32 v237, v218, v219
v_mul_f32 v220, v14, v220
v_mul_f32 v221, v14, v221
v_mfma_f32_32x32x16_bf16 v[32:47], v[76:79], v[228:231], v[32:47]
v_cvt_pk_bf16_f32 v238, v220, v221
v_mul_f32 v222, v14, v222
v_mul_f32 v223, v14, v223
v_cvt_pk_bf16_f32 v239, v222, v223
s_waitcnt vmcnt(2) lgkmcnt(0)
v_mfma_f32_32x32x16_bf16 v[208:223], v[56:59], v[152:155], 0
v_mov_b32 v14, v204
ds_read_b64_tr_b16 v[48:49], v96 offset:8192
ds_read_b64_tr_b16 v[50:51], v96 offset:8704
v_permlane32_swap_b32 v204, v14
v_add_f32 v14, s52, v14
v_rcp_f32 v14, v14
ds_read_b64_tr_b16 v[52:53], v96 offset:9216
s_add_u32 s45, s44, 10240
buffer_load_dwordx4 v[168:171], v5, s[16:19], s45 offen sc1
s_add_u32 s45, s44, 11264
buffer_load_dwordx4 v[172:175], v5, s[16:19], s45 offen sc1
v_mfma_f32_32x32x16_bf16 v[208:223], v[60:63], v[156:159], v[208:223]
ds_read_b64_tr_b16 v[54:55], v96 offset:9728
ds_read_b64_tr_b16 v[64:65], v97 offset:8192
ds_read_b64_tr_b16 v[66:67], v97 offset:9216
v_mul_f32 v192, v14, v192
v_mul_f32 v193, v14, v193
v_cvt_pk_bf16_f32 v224, v192, v193
v_mul_f32 v194, v14, v194
v_mul_f32 v195, v14, v195
v_mfma_f32_32x32x16_bf16 v[16:31], v[80:83], v[232:235], v[16:31]
ds_read_b64_tr_b16 v[68:69], v98 offset:8192
ds_read_b64_tr_b16 v[70:71], v98 offset:9216
ds_read_b64_tr_b16 v[72:73], v97 offset:10240
v_cvt_pk_bf16_f32 v225, v194, v195
v_mul_f32 v196, v14, v196
v_mul_f32 v197, v14, v197
v_cvt_pk_bf16_f32 v226, v196, v197
v_mul_f32 v198, v14, v198
v_mfma_f32_32x32x16_bf16 v[32:47], v[84:87], v[232:235], v[32:47]
ds_read_b64_tr_b16 v[74:75], v97 offset:11264
ds_read_b64_tr_b16 v[76:77], v98 offset:10240
ds_read_b64_tr_b16 v[78:79], v98 offset:11264
v_mul_f32 v199, v14, v199
v_cvt_pk_bf16_f32 v227, v198, v199
v_mul_f32 v200, v14, v200
v_mul_f32 v201, v14, v201
v_cvt_pk_bf16_f32 v228, v200, v201
v_mfma_f32_32x32x16_bf16 v[16:31], v[88:91], v[236:239], v[16:31]
v_mul_f32 v202, v14, v202
v_mul_f32 v203, v14, v203
v_cvt_pk_bf16_f32 v229, v202, v203
v_mul_f32 v204, v14, v204
v_mul_f32 v205, v14, v205
v_mfma_f32_32x32x16_bf16 v[32:47], v[92:95], v[236:239], v[32:47]
v_cvt_pk_bf16_f32 v230, v204, v205
v_mul_f32 v206, v14, v206
v_mul_f32 v207, v14, v207
v_cvt_pk_bf16_f32 v231, v206, v207
s_waitcnt vmcnt(2) lgkmcnt(0)
v_mfma_f32_32x32x16_bf16 v[192:207], v[48:51], v[160:163], 0
v_mov_b32 v14, v220
ds_read_b64_tr_b16 v[56:57], v96 offset:10240
ds_read_b64_tr_b16 v[58:59], v96 offset:10752
v_permlane32_swap_b32 v220, v14
v_add_f32 v14, s52, v14
v_rcp_f32 v14, v14
ds_read_b64_tr_b16 v[60:61], v96 offset:11264
s_add_u32 s45, s44, 12288
buffer_load_dwordx4 v[176:179], v5, s[16:19], s45 offen sc1
s_add_u32 s45, s44, 13312
buffer_load_dwordx4 v[180:183], v5, s[16:19], s45 offen sc1
v_mfma_f32_32x32x16_bf16 v[192:207], v[52:55], v[164:167], v[192:207]
ds_read_b64_tr_b16 v[62:63], v96 offset:11776
ds_read_b64_tr_b16 v[80:81], v97 offset:12288
ds_read_b64_tr_b16 v[82:83], v97 offset:13312
v_mul_f32 v208, v14, v208
v_mul_f32 v209, v14, v209
v_cvt_pk_bf16_f32 v232, v208, v209
v_mul_f32 v210, v14, v210
v_mul_f32 v211, v14, v211
v_mfma_f32_32x32x16_bf16 v[16:31], v[64:67], v[224:227], v[16:31]
ds_read_b64_tr_b16 v[84:85], v98 offset:12288
ds_read_b64_tr_b16 v[86:87], v98 offset:13312
ds_read_b64_tr_b16 v[88:89], v97 offset:14336
v_cvt_pk_bf16_f32 v233, v210, v211
v_mul_f32 v212, v14, v212
v_mul_f32 v213, v14, v213
v_cvt_pk_bf16_f32 v234, v212, v213
v_mul_f32 v214, v14, v214
v_mfma_f32_32x32x16_bf16 v[32:47], v[68:71], v[224:227], v[32:47]
ds_read_b64_tr_b16 v[90:91], v97 offset:15360
ds_read_b64_tr_b16 v[92:93], v98 offset:14336
ds_read_b64_tr_b16 v[94:95], v98 offset:15360
v_mul_f32 v215, v14, v215
v_cvt_pk_bf16_f32 v235, v214, v215
v_mul_f32 v216, v14, v216
v_mul_f32 v217, v14, v217
v_cvt_pk_bf16_f32 v236, v216, v217
v_mfma_f32_32x32x16_bf16 v[16:31], v[72:75], v[228:231], v[16:31]
v_mul_f32 v218, v14, v218
v_mul_f32 v219, v14, v219
v_cvt_pk_bf16_f32 v237, v218, v219
v_mul_f32 v220, v14, v220
v_mul_f32 v221, v14, v221
v_mfma_f32_32x32x16_bf16 v[32:47], v[76:79], v[228:231], v[32:47]
v_cvt_pk_bf16_f32 v238, v220, v221
v_mul_f32 v222, v14, v222
v_mul_f32 v223, v14, v223
v_cvt_pk_bf16_f32 v239, v222, v223
s_waitcnt vmcnt(2) lgkmcnt(0)
v_mfma_f32_32x32x16_bf16 v[208:223], v[56:59], v[168:171], 0
v_mov_b32 v14, v204
ds_read_b64_tr_b16 v[48:49], v96 offset:12288
ds_read_b64_tr_b16 v[50:51], v96 offset:12800
v_permlane32_swap_b32 v204, v14
v_add_f32 v14, s52, v14
v_rcp_f32 v14, v14
ds_read_b64_tr_b16 v[52:53], v96 offset:13312
s_add_u32 s45, s44, 14336
buffer_load_dwordx4 v[184:187], v5, s[16:19], s45 offen sc1
s_add_u32 s45, s44, 15360
buffer_load_dwordx4 v[188:191], v5, s[16:19], s45 offen sc1
v_mfma_f32_32x32x16_bf16 v[208:223], v[60:63], v[172:175], v[208:223]
ds_read_b64_tr_b16 v[54:55], v96 offset:13824
ds_read_b64_tr_b16 v[64:65], v97 offset:16384
ds_read_b64_tr_b16 v[66:67], v97 offset:17408
v_mul_f32 v192, v14, v192
v_mul_f32 v193, v14, v193
v_cvt_pk_bf16_f32 v224, v192, v193
v_mul_f32 v194, v14, v194
v_mul_f32 v195, v14, v195
v_mfma_f32_32x32x16_bf16 v[16:31], v[80:83], v[232:235], v[16:31]
ds_read_b64_tr_b16 v[68:69], v98 offset:16384
ds_read_b64_tr_b16 v[70:71], v98 offset:17408
ds_read_b64_tr_b16 v[72:73], v97 offset:18432
v_cvt_pk_bf16_f32 v225, v194, v195
v_mul_f32 v196, v14, v196
v_mul_f32 v197, v14, v197
v_cvt_pk_bf16_f32 v226, v196, v197
v_mul_f32 v198, v14, v198
v_mfma_f32_32x32x16_bf16 v[32:47], v[84:87], v[232:235], v[32:47]
ds_read_b64_tr_b16 v[74:75], v97 offset:19456
ds_read_b64_tr_b16 v[76:77], v98 offset:18432
ds_read_b64_tr_b16 v[78:79], v98 offset:19456
v_mul_f32 v199, v14, v199
v_cvt_pk_bf16_f32 v227, v198, v199
v_mul_f32 v200, v14, v200
v_mul_f32 v201, v14, v201
v_cvt_pk_bf16_f32 v228, v200, v201
v_mfma_f32_32x32x16_bf16 v[16:31], v[88:91], v[236:239], v[16:31]
v_mul_f32 v202, v14, v202
v_mul_f32 v203, v14, v203
v_cvt_pk_bf16_f32 v229, v202, v203
v_mul_f32 v204, v14, v204
v_mul_f32 v205, v14, v205
v_mfma_f32_32x32x16_bf16 v[32:47], v[92:95], v[236:239], v[32:47]
v_cvt_pk_bf16_f32 v230, v204, v205
v_mul_f32 v206, v14, v206
v_mul_f32 v207, v14, v207
v_cvt_pk_bf16_f32 v231, v206, v207
s_waitcnt vmcnt(2) lgkmcnt(0)
v_mfma_f32_32x32x16_bf16 v[192:207], v[48:51], v[176:179], 0
v_mov_b32 v14, v220
ds_read_b64_tr_b16 v[56:57], v96 offset:14336
ds_read_b64_tr_b16 v[58:59], v96 offset:14848
v_permlane32_swap_b32 v220, v14
v_add_f32 v14, s52, v14
v_rcp_f32 v14, v14
ds_read_b64_tr_b16 v[60:61], v96 offset:15360
v_mfma_f32_32x32x16_bf16 v[192:207], v[52:55], v[180:183], v[192:207]
ds_read_b64_tr_b16 v[62:63], v96 offset:15872
ds_read_b64_tr_b16 v[80:81], v97 offset:20480
ds_read_b64_tr_b16 v[82:83], v97 offset:21504
v_mul_f32 v208, v14, v208
v_mul_f32 v209, v14, v209
v_cvt_pk_bf16_f32 v232, v208, v209
v_mul_f32 v210, v14, v210
v_mul_f32 v211, v14, v211
v_mfma_f32_32x32x16_bf16 v[16:31], v[64:67], v[224:227], v[16:31]
ds_read_b64_tr_b16 v[84:85], v98 offset:20480
ds_read_b64_tr_b16 v[86:87], v98 offset:21504
ds_read_b64_tr_b16 v[88:89], v97 offset:22528
v_cvt_pk_bf16_f32 v233, v210, v211
v_mul_f32 v212, v14, v212
v_mul_f32 v213, v14, v213
v_cvt_pk_bf16_f32 v234, v212, v213
v_mul_f32 v214, v14, v214
v_mfma_f32_32x32x16_bf16 v[32:47], v[68:71], v[224:227], v[32:47]
ds_read_b64_tr_b16 v[90:91], v97 offset:23552
ds_read_b64_tr_b16 v[92:93], v98 offset:22528
ds_read_b64_tr_b16 v[94:95], v98 offset:23552
v_mul_f32 v215, v14, v215
v_cvt_pk_bf16_f32 v235, v214, v215
v_mul_f32 v216, v14, v216
v_mul_f32 v217, v14, v217
v_cvt_pk_bf16_f32 v236, v216, v217
v_mfma_f32_32x32x16_bf16 v[16:31], v[72:75], v[228:231], v[16:31]
v_mul_f32 v218, v14, v218
v_mul_f32 v219, v14, v219
v_cvt_pk_bf16_f32 v237, v218, v219
v_mul_f32 v220, v14, v220
v_mul_f32 v221, v14, v221
v_mfma_f32_32x32x16_bf16 v[32:47], v[76:79], v[228:231], v[32:47]
v_cvt_pk_bf16_f32 v238, v220, v221
v_mul_f32 v222, v14, v222
v_mul_f32 v223, v14, v223
v_cvt_pk_bf16_f32 v239, v222, v223
s_waitcnt vmcnt(0) lgkmcnt(0)
v_mfma_f32_32x32x16_bf16 v[208:223], v[56:59], v[184:187], 0
v_mov_b32 v14, v204
ds_read_b64_tr_b16 v[64:65], v97 offset:24576
ds_read_b64_tr_b16 v[66:67], v97 offset:25600
v_permlane32_swap_b32 v204, v14
v_add_f32 v14, s52, v14
v_rcp_f32 v14, v14
ds_read_b64_tr_b16 v[68:69], v98 offset:24576
v_mfma_f32_32x32x16_bf16 v[208:223], v[60:63], v[188:191], v[208:223]
ds_read_b64_tr_b16 v[70:71], v98 offset:25600
ds_read_b64_tr_b16 v[72:73], v97 offset:26624
v_mul_f32 v192, v14, v192
v_mul_f32 v193, v14, v193
v_cvt_pk_bf16_f32 v224, v192, v193
v_mul_f32 v194, v14, v194
v_mul_f32 v195, v14, v195
v_mfma_f32_32x32x16_bf16 v[16:31], v[80:83], v[232:235], v[16:31]
ds_read_b64_tr_b16 v[74:75], v97 offset:27648
ds_read_b64_tr_b16 v[76:77], v98 offset:26624
v_cvt_pk_bf16_f32 v225, v194, v195
v_mul_f32 v196, v14, v196
v_mul_f32 v197, v14, v197
v_cvt_pk_bf16_f32 v226, v196, v197
v_mul_f32 v198, v14, v198
v_mfma_f32_32x32x16_bf16 v[32:47], v[84:87], v[232:235], v[32:47]
ds_read_b64_tr_b16 v[78:79], v98 offset:27648
v_mul_f32 v199, v14, v199
v_cvt_pk_bf16_f32 v227, v198, v199
v_mul_f32 v200, v14, v200
v_mul_f32 v201, v14, v201
v_cvt_pk_bf16_f32 v228, v200, v201
v_mfma_f32_32x32x16_bf16 v[16:31], v[88:91], v[236:239], v[16:31]
v_mul_f32 v202, v14, v202
v_mul_f32 v203, v14, v203
v_cvt_pk_bf16_f32 v229, v202, v203
v_mul_f32 v204, v14, v204
v_mul_f32 v205, v14, v205
v_mfma_f32_32x32x16_bf16 v[32:47], v[92:95], v[236:239], v[32:47]
v_cvt_pk_bf16_f32 v230, v204, v205
v_mul_f32 v206, v14, v206
v_mul_f32 v207, v14, v207
v_cvt_pk_bf16_f32 v231, v206, v207
s_waitcnt vmcnt(0) lgkmcnt(0)
v_mfma_f32_32x32x16_bf16 v[16:31], v[64:67], v[224:227], v[16:31]
v_mov_b32 v14, v220
ds_read_b64_tr_b16 v[80:81], v97 offset:28672
ds_read_b64_tr_b16 v[82:83], v97 offset:29696
v_permlane32_swap_b32 v220, v14
v_add_f32 v14, s52, v14
v_rcp_f32 v14, v14
ds_read_b64_tr_b16 v[84:85], v98 offset:28672
v_mfma_f32_32x32x16_bf16 v[32:47], v[68:71], v[224:227], v[32:47]
ds_read_b64_tr_b16 v[86:87], v98 offset:29696
ds_read_b64_tr_b16 v[88:89], v97 offset:30720
ds_read_b64_tr_b16 v[90:91], v97 offset:31744
ds_read_b64_tr_b16 v[92:93], v98 offset:30720
ds_read_b64_tr_b16 v[94:95], v98 offset:31744
v_mul_f32 v208, v14, v208
v_mul_f32 v209, v14, v209
v_cvt_pk_bf16_f32 v232, v208, v209
v_mul_f32 v210, v14, v210
v_mul_f32 v211, v14, v211
v_cvt_pk_bf16_f32 v233, v210, v211
v_mul_f32 v212, v14, v212
v_mul_f32 v213, v14, v213
v_mfma_f32_32x32x16_bf16 v[16:31], v[72:75], v[228:231], v[16:31]
v_cvt_pk_bf16_f32 v234, v212, v213
v_mul_f32 v214, v14, v214
v_mul_f32 v215, v14, v215
v_cvt_pk_bf16_f32 v235, v214, v215
v_mul_f32 v216, v14, v216
v_mul_f32 v217, v14, v217
v_cvt_pk_bf16_f32 v236, v216, v217
v_mul_f32 v218, v14, v218
v_mfma_f32_32x32x16_bf16 v[32:47], v[76:79], v[228:231], v[32:47]
v_mul_f32 v219, v14, v219
v_cvt_pk_bf16_f32 v237, v218, v219
v_mul_f32 v220, v14, v220
v_mul_f32 v221, v14, v221
v_cvt_pk_bf16_f32 v238, v220, v221
v_mul_f32 v222, v14, v222
v_mul_f32 v223, v14, v223
v_cvt_pk_bf16_f32 v239, v222, v223
s_waitcnt vmcnt(0) lgkmcnt(0)
v_mfma_f32_32x32x16_bf16 v[16:31], v[80:83], v[232:235], v[16:31]
v_mfma_f32_32x32x16_bf16 v[32:47], v[84:87], v[232:235], v[32:47]
v_mfma_f32_32x32x16_bf16 v[16:31], v[88:91], v[236:239], v[16:31]
v_mfma_f32_32x32x16_bf16 v[32:47], v[92:95], v[236:239], v[32:47]
s_nop 10
ds_write_b128 v240, v[16:19] offset:0
ds_write_b128 v240, v[32:35] offset:4096
ds_write_b128 v241, v[20:23] offset:0
ds_write_b128 v241, v[36:39] offset:4096
ds_write_b128 v242, v[24:27] offset:0
ds_write_b128 v242, v[40:43] offset:4096
ds_write_b128 v243, v[28:31] offset:0
ds_write_b128 v243, v[44:47] offset:4096
s_waitcnt lgkmcnt(0)
s_barrier
ds_read_b128 v[64:67], v244 offset:0
ds_read_b128 v[68:71], v245 offset:0
ds_read_b128 v[72:75], v244 offset:1024
ds_read_b128 v[76:79], v245 offset:1024
ds_read_b128 v[80:83], v244 offset:2048
ds_read_b128 v[84:87], v245 offset:2048
ds_read_b128 v[88:91], v244 offset:3072
ds_read_b128 v[92:95], v245 offset:3072
s_waitcnt lgkmcnt(6)
v_pk_add_f32 v[64:65], v[64:65], v[68:69]
v_pk_add_f32 v[66:67], v[66:67], v[70:71]
s_add_u32 s45, s58, 0
buffer_store_dwordx4 v[64:67], v246, s[20:23], s45 offen sc1
s_waitcnt lgkmcnt(4)
v_pk_add_f32 v[72:73], v[72:73], v[76:77]
v_pk_add_f32 v[74:75], v[74:75], v[78:79]
s_add_u32 s45, s58, 28672
buffer_store_dwordx4 v[72:75], v246, s[20:23], s45 offen sc1
s_waitcnt lgkmcnt(2)
v_pk_add_f32 v[80:81], v[80:81], v[84:85]
v_pk_add_f32 v[82:83], v[82:83], v[86:87]
s_add_u32 s45, s58, 57344
buffer_store_dwordx4 v[80:83], v246, s[20:23], s45 offen sc1
s_waitcnt lgkmcnt(0)
v_pk_add_f32 v[88:89], v[88:89], v[92:93]
v_pk_add_f32 v[90:91], v[90:91], v[94:95]
s_add_u32 s45, s58, 86016
buffer_store_dwordx4 v[88:91], v246, s[20:23], s45 offen sc1
LB_end:
s_endpgm
L_BL:
s_sub_u32 s7, s6, 4
v_lshrrev_b32 v1, 3, v0
v_and_b32 v2, 7, v0
v_lshrrev_b32 v3, 1, v1
v_xor_b32 v4, v2, v3
v_xor_b32 v5, 4, v4
v_lshlrev_b32 v4, 4, v4
v_lshlrev_b32 v5, 4, v5
s_lshl_b32 s3, s4, 7
s_lshl_b32 s40, s7, 5
s_add_u32 s3, s3, s40
v_add_u32 v6, s3, v1
v_mul_u32_u24 v6, 896, v6
v_add_u32 v10, 0, v6
v_add_u32 v10, v10, v4
v_add_u32 v11, 7168, v6
v_add_u32 v11, v11, v5
v_add_u32 v12, 14336, v6
v_add_u32 v12, v12, v4
v_add_u32 v13, 21504, v6
v_add_u32 v13, v13, v5
v_and_b32 v7, 1, v3
v_lshlrev_b32 v7, 2, v7
v_xor_b32 v7, v7, v2
v_lshlrev_b32 v7, 4, v7
s_lshl_b32 s3, s7, 4
v_add_u32 v6, s3, v1
v_mul_u32_u24 v6, 2688, v6
v_add_u32 v6, v6, v7
s_mul_i32 s3, s5, 112
v_add_u32 v14, s3, v6
v_mov_b32 v9, 0x7fffff00
v_cmp_eq_u32 vcc, 0x70, v7
s_nop 1
v_cndmask_b32 v14, v14, v9, vcc
s_lshl_b32 s40, s7, 12
s_lshl_b32 s49, s7, 11
s_mov_b32 s47, 0
s_mov_b32 s54, s47
s_waitcnt lgkmcnt(0)
s_mov_b32 s8, s82
s_mov_b32 s9, s83
s_mov_b32 s10, 0x1c0000
s_mov_b32 s11, 0x20000
s_mov_b32 s12, s84
s_mov_b32 s13, s85
s_mov_b32 s14, 0x126000
s_mov_b32 s15, 0x20000
s_lshl_b32 s41, s47, 7
s_mul_i32 s48, s47, 172032
s_add_u32 s47, s47, 1
s_cmp_eq_u32 s47, 7
s_cselect_b32 s47, 0, s47
s_add_u32 m0, s40, 0
s_nop 0
buffer_load_dwordx4 v10, s[8:11], s41 offen nt lds
s_add_u32 m0, s40, 1024
s_nop 0
buffer_load_dwordx4 v11, s[8:11], s41 offen nt lds
s_add_u32 m0, s40, 2048
s_nop 0
buffer_load_dwordx4 v12, s[8:11], s41 offen nt lds
s_add_u32 m0, s40, 3072
s_nop 0
buffer_load_dwordx4 v13, s[8:11], s41 offen nt lds
s_add_u32 m0, s49, 114688
s_add_u32 s41, s48, 896
buffer_load_dwordx4 v14, s[12:15], s41 offen lds
s_add_u32 m0, s49, 115712
s_add_u32 s41, s48, 22400
buffer_load_dwordx4 v14, s[12:15], s41 offen lds
s_add_u32 m0, s49, 122880
s_add_u32 s41, s48, 1792
buffer_load_dwordx4 v14, s[12:15], s41 offen lds
s_add_u32 m0, s49, 123904
s_add_u32 s41, s48, 23296
buffer_load_dwordx4 v14, s[12:15], s41 offen lds
s_lshl_b32 s3, s7, 3
v_add_u32 v8, s3, v1
v_mul_u32_u24 v9, 896, v8
v_add_u32 v9, v9, v7
s_lshl_b32 s3, s5, 7
v_add_u32 v9, s3, v9
v_mov_b32 v15, 0x7fffff00
v_cmp_lt_u32 vcc, 27, v8
s_nop 1
v_cndmask_b32 v15, v9, v15, vcc
s_and_b32 s3, s4, 3
s_lshl_b32 s3, s3, 3
s_add_u32 s28, s3, s5
v_mov_b32 v9, 0x7fffff00
s_lshl_b32 s3, s4, 7
s_lshl_b32 s29, s5, 4
s_add_u32 s3, s3, s29
v_add_u32 v6, s3, v0
v_mul_u32_u24 v6, 896, v6
v_cmp_gt_u32 vcc, 16, v0
s_nop 1
v_cndmask_b32 v22, v9, v6, vcc
v_cmp_le_u32 vcc, 14, v0
s_nop 1
v_cndmask_b32 v6, 0, 1, vcc
v_mul_u32_u24 v8, 14, v6
v_sub_u32 v8, v0, v8
v_lshlrev_b32 v8, 7, v8
s_lshl_b32 s3, s28, 1
v_add_u32 v6, s3, v6
v_mul_u32_u24 v6, 2688, v6
v_add_u32 v6, v6, v8
v_add_u32 v6, 896, v6
v_cmp_gt_u32 vcc, 28, v0
s_nop 1
v_cndmask_b32 v23, v9, v6, vcc
s_cmp_eq_u32 s7, 0
s_cselect_b64 vcc, -1, 0
v_cndmask_b32 v22, v23, v22, vcc
s_cmp_lt_u32 s7, 2
s_cselect_b64 vcc, -1, 0
v_cndmask_b32 v22, v9, v22, vcc
v_mul_u32_u24 v6, 37, v0
v_lshrrev_b32 v6, 8, v6
v_mul_u32_u24 v8, 7, v6
v_sub_u32 v8, v0, v8
v_lshlrev_b32 v8, 7, v8
s_and_b32 s3, s4, 3
s_lshl_b32 s3, s3, 1
s_cmp_eq_u32 s5, 7
s_cselect_b32 s29, 1, 0
s_add_u32 s3, s3, s29
s_mul_i32 s3, s3, 56
s_mul_i32 s29, s7, 14
s_add_u32 s3, s3, s29
v_add_u32 v6, s3, v6
v_mul_u32_u24 v6, 896, v6
v_add_u32 v6, v6, v8
v_cmp_gt_u32 vcc, 49, v0
s_nop 1
v_cndmask_b32 v23, v9, v6, vcc
s_add_u32 s3, s5, 1
s_and_b32 s3, s3, 7
s_cmp_lt_u32 s3, 2
s_cselect_b64 vcc, -1, 0
v_cndmask_b32 v23, v9, v23, vcc
s_mov_b32 s26, 0x126000
s_mov_b32 s33, 172032
s_cmp_eq_u32 s7, 0
s_cselect_b32 s24, s82, s84
s_cselect_b32 s25, s83, s85
s_cselect_b32 s26, 0x1c0000, s26
s_cselect_b32 s33, 128, s33
s_mov_b32 s27, 0x20000
s_mov_b32 s28, s86
s_mov_b32 s29, s87
s_mov_b32 s30, 0x62000
s_mov_b32 s31, 0x20000
s_mul_i32 s41, s33, 1
s_cmp_eq_u32 s7, 0
s_cbranch_scc1 LBL_pf1_a
buffer_load_dword v254, v22, s[24:27], s41 offen
s_branch LBL_pf1_b
LBL_pf1_a:
buffer_load_dword v254, v22, s[24:27], s41 offen nt
LBL_pf1_b:
s_mul_i32 s41, s33, 2
s_cmp_eq_u32 s7, 0
s_cbranch_scc1 LBL_pf2_a
buffer_load_dword v254, v22, s[24:27], s41 offen
s_branch LBL_pf2_b
LBL_pf2_a:
buffer_load_dword v254, v22, s[24:27], s41 offen nt
LBL_pf2_b:
s_mul_i32 s41, s33, 3
s_cmp_eq_u32 s7, 0
s_cbranch_scc1 LBL_pf3_a
buffer_load_dword v254, v22, s[24:27], s41 offen
s_branch LBL_pf3_b
LBL_pf3_a:
buffer_load_dword v254, v22, s[24:27], s41 offen nt
LBL_pf3_b:
s_waitcnt vmcnt(3)
s_barrier
s_lshl_b32 s41, s47, 7
s_mul_i32 s48, s47, 172032
s_add_u32 s47, s47, 1
s_cmp_eq_u32 s47, 7
s_cselect_b32 s47, 0, s47
s_add_u32 m0, s40, 16384
s_nop 0
buffer_load_dwordx4 v10, s[8:11], s41 offen nt lds
s_add_u32 m0, s40, 17408
s_nop 0
buffer_load_dwordx4 v11, s[8:11], s41 offen nt lds
s_add_u32 m0, s40, 18432
s_nop 0
buffer_load_dwordx4 v12, s[8:11], s41 offen nt lds
s_add_u32 m0, s40, 19456
s_nop 0
buffer_load_dwordx4 v13, s[8:11], s41 offen nt lds
s_add_u32 m0, s49, 131072
s_add_u32 s41, s48, 896
buffer_load_dwordx4 v14, s[12:15], s41 offen lds
s_add_u32 m0, s49, 132096
s_add_u32 s41, s48, 22400
buffer_load_dwordx4 v14, s[12:15], s41 offen lds
s_add_u32 m0, s49, 139264
s_add_u32 s41, s48, 1792
buffer_load_dwordx4 v14, s[12:15], s41 offen lds
s_add_u32 m0, s49, 140288
s_add_u32 s41, s48, 23296
buffer_load_dwordx4 v14, s[12:15], s41 offen lds
s_lshl_b32 s41, s47, 7
s_mul_i32 s48, s47, 172032
s_add_u32 s47, s47, 1
s_cmp_eq_u32 s47, 7
s_cselect_b32 s47, 0, s47
s_add_u32 m0, s40, 32768
s_nop 0
buffer_load_dwordx4 v10, s[8:11], s41 offen nt lds
s_add_u32 m0, s40, 33792
s_nop 0
buffer_load_dwordx4 v11, s[8:11], s41 offen nt lds
s_add_u32 m0, s40, 34816
s_nop 0
buffer_load_dwordx4 v12, s[8:11], s41 offen nt lds
s_add_u32 m0, s40, 35840
s_nop 0
buffer_load_dwordx4 v13, s[8:11], s41 offen nt lds
s_add_u32 m0, s49, 147456
s_add_u32 s41, s48, 896
buffer_load_dwordx4 v14, s[12:15], s41 offen lds
s_add_u32 m0, s49, 148480
s_add_u32 s41, s48, 22400
buffer_load_dwordx4 v14, s[12:15], s41 offen lds
s_add_u32 m0, s49, 155648
s_add_u32 s41, s48, 1792
buffer_load_dwordx4 v14, s[12:15], s41 offen lds
s_add_u32 m0, s49, 156672
s_add_u32 s41, s48, 23296
buffer_load_dwordx4 v14, s[12:15], s41 offen lds
s_mul_i32 s41, s33, 4
s_cmp_eq_u32 s7, 0
s_cbranch_scc1 LBL_pf4_a
buffer_load_dword v254, v22, s[24:27], s41 offen
s_branch LBL_pf4_b
LBL_pf4_a:
buffer_load_dword v254, v22, s[24:27], s41 offen nt
LBL_pf4_b:
s_waitcnt vmcnt(9)
s_barrier
s_lshl_b32 s41, s47, 7
s_mul_i32 s48, s47, 172032
s_add_u32 s47, s47, 1
s_cmp_eq_u32 s47, 7
s_cselect_b32 s47, 0, s47
s_add_u32 m0, s40, 49152
s_nop 0
buffer_load_dwordx4 v10, s[8:11], s41 offen nt lds
s_add_u32 m0, s40, 50176
s_nop 0
buffer_load_dwordx4 v11, s[8:11], s41 offen nt lds
s_add_u32 m0, s40, 51200
s_nop 0
buffer_load_dwordx4 v12, s[8:11], s41 offen nt lds
s_add_u32 m0, s40, 52224
s_nop 0
buffer_load_dwordx4 v13, s[8:11], s41 offen nt lds
s_add_u32 m0, s49, 114688
s_add_u32 s41, s48, 896
buffer_load_dwordx4 v14, s[12:15], s41 offen lds
s_add_u32 m0, s49, 115712
s_add_u32 s41, s48, 22400
buffer_load_dwordx4 v14, s[12:15], s41 offen lds
s_add_u32 m0, s49, 122880
s_add_u32 s41, s48, 1792
buffer_load_dwordx4 v14, s[12:15], s41 offen lds
s_add_u32 m0, s49, 123904
s_add_u32 s41, s48, 23296
buffer_load_dwordx4 v14, s[12:15], s41 offen lds
s_mul_i32 s41, s33, 5
s_cmp_eq_u32 s7, 0
s_cbranch_scc1 LBL_pf5_a
buffer_load_dword v254, v22, s[24:27], s41 offen
s_branch LBL_pf5_b
LBL_pf5_a:
buffer_load_dword v254, v22, s[24:27], s41 offen nt
LBL_pf5_b:
s_waitcnt vmcnt(10)
s_barrier
s_lshl_b32 s41, s47, 7
s_mul_i32 s48, s47, 172032
s_add_u32 s47, s47, 1
s_cmp_eq_u32 s47, 7
s_cselect_b32 s47, 0, s47
s_add_u32 m0, s40, 65536
s_nop 0
buffer_load_dwordx4 v10, s[8:11], s41 offen nt lds
s_add_u32 m0, s40, 66560
s_nop 0
buffer_load_dwordx4 v11, s[8:11], s41 offen nt lds
s_add_u32 m0, s40, 67584
s_nop 0
buffer_load_dwordx4 v12, s[8:11], s41 offen nt lds
s_add_u32 m0, s40, 68608
s_nop 0
buffer_load_dwordx4 v13, s[8:11], s41 offen nt lds
s_add_u32 m0, s49, 131072
s_add_u32 s41, s48, 896
buffer_load_dwordx4 v14, s[12:15], s41 offen lds
s_add_u32 m0, s49, 132096
s_add_u32 s41, s48, 22400
buffer_load_dwordx4 v14, s[12:15], s41 offen lds
s_add_u32 m0, s49, 139264
s_add_u32 s41, s48, 1792
buffer_load_dwordx4 v14, s[12:15], s41 offen lds
s_add_u32 m0, s49, 140288
s_add_u32 s41, s48, 23296
buffer_load_dwordx4 v14, s[12:15], s41 offen lds
s_mul_i32 s41, s33, 6
s_cmp_eq_u32 s7, 0
s_cbranch_scc1 LBL_pf6_a
buffer_load_dword v254, v22, s[24:27], s41 offen
s_branch LBL_pf6_b
LBL_pf6_a:
buffer_load_dword v254, v22, s[24:27], s41 offen nt
LBL_pf6_b:
s_waitcnt vmcnt(10)
s_barrier
s_lshl_b32 s41, s47, 7
s_mul_i32 s48, s47, 172032
s_add_u32 s47, s47, 1
s_cmp_eq_u32 s47, 7
s_cselect_b32 s47, 0, s47
s_add_u32 m0, s40, 81920
s_nop 0
buffer_load_dwordx4 v10, s[8:11], s41 offen nt lds
s_add_u32 m0, s40, 82944
s_nop 0
buffer_load_dwordx4 v11, s[8:11], s41 offen nt lds
s_add_u32 m0, s40, 83968
s_nop 0
buffer_load_dwordx4 v12, s[8:11], s41 offen nt lds
s_add_u32 m0, s40, 84992
s_nop 0
buffer_load_dwordx4 v13, s[8:11], s41 offen nt lds
s_add_u32 m0, s49, 147456
s_add_u32 s41, s48, 896
buffer_load_dwordx4 v14, s[12:15], s41 offen lds
s_add_u32 m0, s49, 148480
s_add_u32 s41, s48, 22400
buffer_load_dwordx4 v14, s[12:15], s41 offen lds
s_add_u32 m0, s49, 155648
s_add_u32 s41, s48, 1792
buffer_load_dwordx4 v14, s[12:15], s41 offen lds
s_add_u32 m0, s49, 156672
s_add_u32 s41, s48, 23296
buffer_load_dwordx4 v14, s[12:15], s41 offen lds
s_waitcnt vmcnt(9)
s_barrier
v_lshlrev_b32 v20, 2, v0
global_load_dword v21, v20, s[90:91] sc1
s_lshl_b32 s41, s47, 7
s_mul_i32 s48, s47, 172032
s_add_u32 s47, s47, 1
s_cmp_eq_u32 s47, 7
s_cselect_b32 s47, 0, s47
s_add_u32 m0, s40, 98304
s_nop 0
buffer_load_dwordx4 v10, s[8:11], s41 offen nt lds
s_add_u32 m0, s40, 99328
s_nop 0
buffer_load_dwordx4 v11, s[8:11], s41 offen nt lds
s_add_u32 m0, s40, 100352
s_nop 0
buffer_load_dwordx4 v12, s[8:11], s41 offen nt lds
s_add_u32 m0, s40, 101376
s_nop 0
buffer_load_dwordx4 v13, s[8:11], s41 offen nt lds
s_add_u32 m0, s49, 114688
s_add_u32 s41, s48, 896
buffer_load_dwordx4 v14, s[12:15], s41 offen lds
s_add_u32 m0, s49, 115712
s_add_u32 s41, s48, 22400
buffer_load_dwordx4 v14, s[12:15], s41 offen lds
s_add_u32 m0, s49, 122880
s_add_u32 s41, s48, 1792
buffer_load_dwordx4 v14, s[12:15], s41 offen lds
s_add_u32 m0, s49, 123904
s_add_u32 s41, s48, 23296
buffer_load_dwordx4 v14, s[12:15], s41 offen lds
buffer_load_dword v254, v23, s[28:31], 0 offen
s_movk_i32 s41, 6272
buffer_load_dword v254, v23, s[28:31], s41 offen
s_waitcnt vmcnt(11)
s_barrier
s_waitcnt vmcnt(2)
s_barrier
s_mov_b32 s47, s54
s_mul_i32 s48, s47, 172032
s_add_u32 s47, s47, 1
s_cmp_eq_u32 s47, 7
s_cselect_b32 s47, 0, s47
s_add_u32 m0, s49, 131072
s_add_u32 s41, s48, 0
buffer_load_dwordx4 v14, s[12:15], s41 offen lds
s_add_u32 m0, s49, 132096
s_add_u32 s41, s48, 21504
buffer_load_dwordx4 v14, s[12:15], s41 offen lds
s_mul_i32 s48, s47, 172032
s_add_u32 s47, s47, 1
s_cmp_eq_u32 s47, 7
s_cselect_b32 s47, 0, s47
s_add_u32 m0, s49, 139264
s_add_u32 s41, s48, 0
buffer_load_dwordx4 v14, s[12:15], s41 offen lds
s_add_u32 m0, s49, 140288
s_add_u32 s41, s48, 21504
buffer_load_dwordx4 v14, s[12:15], s41 offen lds
s_mul_i32 s48, s47, 172032
s_add_u32 s47, s47, 1
s_cmp_eq_u32 s47, 7
s_cselect_b32 s47, 0, s47
s_add_u32 m0, s49, 147456
s_add_u32 s41, s48, 0
buffer_load_dwordx4 v14, s[12:15], s41 offen lds
s_add_u32 m0, s49, 148480
s_add_u32 s41, s48, 21504
buffer_load_dwordx4 v14, s[12:15], s41 offen lds
s_mul_i32 s48, s47, 172032
s_add_u32 s47, s47, 1
s_cmp_eq_u32 s47, 7
s_cselect_b32 s47, 0, s47
s_add_u32 m0, s49, 155648
s_add_u32 s41, s48, 0
buffer_load_dwordx4 v14, s[12:15], s41 offen lds
s_add_u32 m0, s49, 156672
s_add_u32 s41, s48, 21504
buffer_load_dwordx4 v14, s[12:15], s41 offen lds
s_and_b32 s3, s4, 3
s_lshl_b32 s3, s3, 5
s_add_u32 s3, s3, 320
v_lshrrev_b32 v6, 1, v0
v_add_u32 v6, s3, v6
v_mul_u32_u24 v6, 2688, v6
s_mul_i32 s3, s5, 112
s_and_b32 s3, s3, 0xffffff80
v_and_b32 v8, 1, v0
v_lshlrev_b32 v8, 7, v8
v_add_u32 v6, v6, v8
v_add_u32 v6, s3, v6
s_cmp_eq_u32 s7, 0
s_cselect_b32 s41, 0, 0x7fffff00
buffer_load_dword v254, v6, s[12:15], s41 offen
s_barrier
s_mul_i32 s48, s47, 172032
s_add_u32 s47, s47, 1
s_cmp_eq_u32 s47, 7
s_cselect_b32 s47, 0, s47
s_add_u32 m0, s49, 122880
s_add_u32 s41, s48, 0
buffer_load_dwordx4 v14, s[12:15], s41 offen lds
s_add_u32 m0, s49, 123904
s_add_u32 s41, s48, 21504
buffer_load_dwordx4 v14, s[12:15], s41 offen lds
s_mov_b32 s46, 0
s_branch LBL_zd_chk
LBL_zd:
s_sleep 1
global_load_dword v21, v20, s[90:91] sc1
s_waitcnt vmcnt(0)
LBL_zd_chk:
v_cmp_ne_u32 vcc, 0, v21
s_and_b32 s42, vcc_lo, 0xffff
s_cmp_eq_u32 s42, 0xffff
s_cbranch_scc1 LBL_zd_ok
s_add_u32 s46, s46, 1
s_cmp_lt_u32 s46, 0x40000
s_cbranch_scc1 LBL_zd
LBL_zd_ok:
s_waitcnt vmcnt(0)
s_barrier
s_barrier
s_mul_i32 s48, s47, 172032
s_add_u32 s47, s47, 1
s_cmp_eq_u32 s47, 7
s_cselect_b32 s47, 0, s47
s_add_u32 m0, s49, 131072
s_add_u32 s41, s48, 0
buffer_load_dwordx4 v14, s[12:15], s41 offen lds
s_add_u32 m0, s49, 132096
s_add_u32 s41, s48, 21504
buffer_load_dwordx4 v14, s[12:15], s41 offen lds
s_mul_i32 s48, s47, 172032
s_add_u32 s47, s47, 1
s_cmp_eq_u32 s47, 7
s_cselect_b32 s47, 0, s47
s_add_u32 m0, s49, 139264
s_add_u32 s41, s48, 0
buffer_load_dwordx4 v14, s[12:15], s41 offen lds
s_add_u32 m0, s49, 140288
s_add_u32 s41, s48, 21504
buffer_load_dwordx4 v14, s[12:15], s41 offen lds
s_waitcnt vmcnt(0)
s_barrier
v_mov_b32 v20, 163824
v_mov_b32 v21, 0
ds_write_b32 v20, v21
v_mov_b32 v20, 163808
ds_write_b32 v20, v21
s_waitcnt lgkmcnt(0)
s_barrier
s_cmp_eq_u32 s5, 7
s_cbranch_scc1 LBL_j7
s_mov_b32 s20, s88
s_mov_b32 s21, s89
s_mov_b32 s22, 0x700000
s_mov_b32 s23, 0x20000
v_lshrrev_b32 v4, 4, v0
v_and_b32 v6, 1, v4
v_lshrrev_b32 v4, 1, v4
v_and_b32 v7, 15, v0
v_lshrrev_b32 v7, 2, v7
v_and_b32 v8, 3, v0
v_lshlrev_b32 v4, 2, v4
v_add_u32 v4, v4, v7
v_lshlrev_b32 v6, 5, v6
v_lshlrev_b32 v8, 3, v8
v_add_u32 v6, v6, v8
s_lshr_b32 s7, s6, 2
s_lshl_b32 s3, s7, 14
s_add_u32 s3, s3, 65536
v_lshlrev_b32 v9, 6, v4
v_add_u32 v9, v9, v6
v_add_u32 v96, s3, v9
s_lshl_b32 s3, s7, 15
v_lshrrev_b32 v7, 1, v7
v_lshlrev_b32 v7, 6, v7
v_lshlrev_b32 v10, 7, v4
v_add_u32 v10, s3, v10
v_xor_b32 v11, v6, v7
v_add_u32 v97, v11, v10
v_add_u32 v11, 64, v6
v_xor_b32 v11, v11, v7
v_add_u32 v98, v11, v10
v_and_b32 v1, 31, v0
v_lshrrev_b32 v2, 5, v0
v_and_b32 v3, 7, v1
v_lshlrev_b32 v4, 7, v1
s_lshl_b32 s3, s6, 13
s_add_u32 s3, s3, 98304
v_add_u32 v4, s3, v4
v_add_u32 v6, 0, v2
v_xor_b32 v6, v6, v3
v_lshlrev_b32 v6, 4, v6
v_add_u32 v240, v6, v4
v_add_u32 v6, 2, v2
v_xor_b32 v6, v6, v3
v_lshlrev_b32 v6, 4, v6
v_add_u32 v241, v6, v4
v_add_u32 v6, 4, v2
v_xor_b32 v6, v6, v3
v_lshlrev_b32 v6, 4, v6
v_add_u32 v242, v6, v4
v_add_u32 v6, 6, v2
v_xor_b32 v6, v6, v3
v_lshlrev_b32 v6, 4, v6
v_add_u32 v243, v6, v4
v_lshlrev_b32 v6, 4, v0
s_lshr_b32 s7, s6, 2
s_lshl_b32 s7, s7, 12
s_lshl_b32 s3, s6, 13
s_add_u32 s3, s3, s7
s_add_u32 s3, s3, 98304
v_add_u32 v244, s3, v6
s_xor_b32 s3, s6, 4
s_lshl_b32 s3, s3, 13
s_add_u32 s3, s3, s7
s_add_u32 s3, s3, 98304
v_add_u32 v245, s3, v6
v_lshrrev_b32 v9, 3, v0
v_and_b32 v10, 7, v0
v_xor_b32 v10, v10, v9
v_lshlrev_b32 v10, 4, v10
v_mul_u32_u24 v9, 3584, v9
v_add_u32 v246, v9, v10
s_and_b32 s7, s6, 3
s_lshl_b32 s7, s7, 5
s_lshl_b32 s3, s4, 7
s_add_u32 s3, s3, s7
s_mul_i32 s3, s3, 3584
s_lshl_b32 s7, s5, 8
s_add_u32 s3, s3, s7
s_lshr_b32 s7, s6, 2
s_lshl_b32 s7, s7, 7
s_add_u32 s3, s3, s7
s_add_u32 s58, s3, 1792
s_sub_u32 s7, s6, 4
s_mov_b32 s8, s86
s_mov_b32 s9, s87
s_mov_b32 s10, 0x62000
s_mov_b32 s11, 0x20000
s_lshl_b32 s40, s7, 10
s_mov_b32 s41, 0
s_add_u32 m0, s40, 0
s_nop 0
buffer_load_dwordx4 v15, s[8:11], s41 offen lds
s_mov_b32 s41, 25088
s_add_u32 m0, s40, 4096
s_nop 0
buffer_load_dwordx4 v15, s[8:11], s41 offen lds
s_mov_b32 s41, 50176
s_add_u32 m0, s40, 8192
s_nop 0
buffer_load_dwordx4 v15, s[8:11], s41 offen lds
s_mov_b32 s41, 75264
s_add_u32 m0, s40, 12288
s_nop 0
buffer_load_dwordx4 v15, s[8:11], s41 offen lds
s_mov_b32 s41, 100352
s_add_u32 m0, s40, 16384
s_nop 0
buffer_load_dwordx4 v15, s[8:11], s41 offen lds
s_mov_b32 s41, 125440
s_add_u32 m0, s40, 20480
s_nop 0
buffer_load_dwordx4 v15, s[8:11], s41 offen lds
s_mov_b32 s41, 150528
s_add_u32 m0, s40, 24576
s_nop 0
buffer_load_dwordx4 v15, s[8:11], s41 offen lds
s_mov_b32 s41, 175616
s_add_u32 m0, s40, 28672
s_nop 0
buffer_load_dwordx4 v15, s[8:11], s41 offen lds
s_mov_b32 s41, 200704
s_add_u32 m0, s40, 32768
s_nop 0
buffer_load_dwordx4 v15, s[8:11], s41 offen lds
s_mov_b32 s41, 225792
s_add_u32 m0, s40, 36864
s_nop 0
buffer_load_dwordx4 v15, s[8:11], s41 offen lds
s_mov_b32 s41, 250880
s_add_u32 m0, s40, 40960
s_nop 0
buffer_load_dwordx4 v15, s[8:11], s41 offen lds
s_mov_b32 s41, 275968
s_add_u32 m0, s40, 45056
s_nop 0
buffer_load_dwordx4 v15, s[8:11], s41 offen lds
s_mov_b32 s41, 301056
s_add_u32 m0, s40, 49152
s_nop 0
buffer_load_dwordx4 v15, s[8:11], s41 offen lds
s_mov_b32 s41, 326144
s_add_u32 m0, s40, 53248
s_nop 0
buffer_load_dwordx4 v15, s[8:11], s41 offen lds
s_mov_b32 s41, 351232
s_add_u32 m0, s40, 57344
s_nop 0
buffer_load_dwordx4 v15, s[8:11], s41 offen lds
s_mov_b32 s41, 376320
s_add_u32 m0, s40, 61440
s_nop 0
buffer_load_dwordx4 v15, s[8:11], s41 offen lds
s_mov_b32 s16, s92
s_mov_b32 s17, s93
s_mov_b32 s18, 0x800000
s_mov_b32 s19, 0x20000
v_lshrrev_b32 v20, 1, v0
v_lshlrev_b32 v20, 3, v20
v_and_b32 v21, 1, v0
v_add_u32 v20, v20, v21
s_lshl_b32 s3, s7, 1
v_add_u32 v20, s3, v20
v_lshlrev_b32 v20, 7, v20
s_mov_b32 s45, 0x10000
s_mov_b32 exec_hi, 0
s_mov_b32 s46, 0
LBL_pb:
buffer_load_dword v22, v20, s[16:19], s45 offen sc1
s_waitcnt vmcnt(0)
v_cmp_ne_u32 vcc, 0, v22
s_cmp_eq_u64 vcc, exec
s_cbranch_scc1 LBL_pb_ok
s_add_u32 s46, s46, 1
s_cmp_lt_u32 s46, 0x40000
s_cbranch_scc1 LBL_pb
LBL_pb_ok:
s_mov_b64 exec, -1
v_lshlrev_b32 v5, 4, v0
s_lshl_b32 s3, s7, 14
s_add_u32 s44, s3, 0x20000
v_and_b32 v8, 8, v0
v_cmp_ne_u32 vcc, 0, v8
v_mov_b32 v8, 0x7fffff00
s_nop 0
v_cndmask_b32 v8, v5, v8, vcc
s_add_u32 s45, s44, 0
buffer_load_dwordx4 v[32:35], v5, s[16:19], s45 offen sc1
s_add_u32 s45, s44, 1024
buffer_load_dwordx4 v[36:39], v5, s[16:19], s45 offen sc1
s_add_u32 s45, s44, 2048
buffer_load_dwordx4 v[40:43], v5, s[16:19], s45 offen sc1
s_add_u32 s45, s44, 3072
buffer_load_dwordx4 v[44:47], v8, s[16:19], s45 offen sc1
s_add_u32 s45, s44, 4096
buffer_load_dwordx4 v[48:51], v5, s[16:19], s45 offen sc1
s_add_u32 s45, s44, 5120
buffer_load_dwordx4 v[52:55], v5, s[16:19], s45 offen sc1
s_add_u32 s45, s44, 6144
buffer_load_dwordx4 v[56:59], v5, s[16:19], s45 offen sc1
s_add_u32 s45, s44, 7168
buffer_load_dwordx4 v[60:63], v8, s[16:19], s45 offen sc1
s_add_u32 s45, s44, 8192
buffer_load_dwordx4 v[64:67], v5, s[16:19], s45 offen sc1
s_add_u32 s45, s44, 9216
buffer_load_dwordx4 v[68:71], v5, s[16:19], s45 offen sc1
s_add_u32 s45, s44, 10240
buffer_load_dwordx4 v[72:75], v5, s[16:19], s45 offen sc1
s_add_u32 s45, s44, 11264
buffer_load_dwordx4 v[76:79], v8, s[16:19], s45 offen sc1
s_add_u32 s45, s44, 12288
buffer_load_dwordx4 v[80:83], v5, s[16:19], s45 offen sc1
s_add_u32 s45, s44, 13312
buffer_load_dwordx4 v[84:87], v5, s[16:19], s45 offen sc1
s_add_u32 s45, s44, 14336
buffer_load_dwordx4 v[88:91], v5, s[16:19], s45 offen sc1
s_add_u32 s45, s44, 15360
buffer_load_dwordx4 v[92:95], v8, s[16:19], s45 offen sc1
s_mov_b32 s52, 0x358637bd
v_lshrrev_b32 v6, 3, v0
v_and_b32 v6, 1, v6
v_lshlrev_b32 v6, 2, v6
v_lshrrev_b32 v7, 4, v0
v_add_u32 v6, v6, v7
v_lshlrev_b32 v6, 6, v6
v_and_b32 v7, 7, v0
v_lshlrev_b32 v7, 3, v7
v_add_u32 v6, v6, v7
s_lshl_b32 s3, s7, 13
s_add_u32 s3, s3, 65536
v_add_u32 v6, s3, v6
s_waitcnt vmcnt(15)
v_cvt_pk_bf16_f32 v32, v32, v33
v_cvt_pk_bf16_f32 v33, v34, v35
ds_write_b64 v6, v[32:33] offset:0
s_waitcnt vmcnt(14)
v_cvt_pk_bf16_f32 v36, v36, v37
v_cvt_pk_bf16_f32 v37, v38, v39
ds_write_b64 v6, v[36:37] offset:512
s_waitcnt vmcnt(13)
v_cvt_pk_bf16_f32 v40, v40, v41
v_cvt_pk_bf16_f32 v41, v42, v43
ds_write_b64 v6, v[40:41] offset:1024
s_waitcnt vmcnt(12)
v_cvt_pk_bf16_f32 v44, v44, v45
v_cvt_pk_bf16_f32 v45, v46, v47
ds_write_b64 v6, v[44:45] offset:1536
s_waitcnt vmcnt(11)
v_cvt_pk_bf16_f32 v48, v48, v49
v_cvt_pk_bf16_f32 v49, v50, v51
ds_write_b64 v6, v[48:49] offset:2048
s_waitcnt vmcnt(10)
v_cvt_pk_bf16_f32 v52, v52, v53
v_cvt_pk_bf16_f32 v53, v54, v55
ds_write_b64 v6, v[52:53] offset:2560
s_waitcnt vmcnt(9)
v_cvt_pk_bf16_f32 v56, v56, v57
v_cvt_pk_bf16_f32 v57, v58, v59
ds_write_b64 v6, v[56:57] offset:3072
s_waitcnt vmcnt(8)
v_cvt_pk_bf16_f32 v60, v60, v61
v_cvt_pk_bf16_f32 v61, v62, v63
ds_write_b64 v6, v[60:61] offset:3584
s_waitcnt vmcnt(7)
v_cvt_pk_bf16_f32 v64, v64, v65
v_cvt_pk_bf16_f32 v65, v66, v67
ds_write_b64 v6, v[64:65] offset:4096
s_waitcnt vmcnt(6)
v_cvt_pk_bf16_f32 v68, v68, v69
v_cvt_pk_bf16_f32 v69, v70, v71
ds_write_b64 v6, v[68:69] offset:4608
s_waitcnt vmcnt(5)
v_cvt_pk_bf16_f32 v72, v72, v73
v_cvt_pk_bf16_f32 v73, v74, v75
ds_write_b64 v6, v[72:73] offset:5120
s_waitcnt vmcnt(4)
v_cvt_pk_bf16_f32 v76, v76, v77
v_cvt_pk_bf16_f32 v77, v78, v79
ds_write_b64 v6, v[76:77] offset:5632
s_waitcnt vmcnt(3)
v_cvt_pk_bf16_f32 v80, v80, v81
v_cvt_pk_bf16_f32 v81, v82, v83
ds_write_b64 v6, v[80:81] offset:6144
s_waitcnt vmcnt(2)
v_cvt_pk_bf16_f32 v84, v84, v85
v_cvt_pk_bf16_f32 v85, v86, v87
ds_write_b64 v6, v[84:85] offset:6656
s_waitcnt vmcnt(1)
v_cvt_pk_bf16_f32 v88, v88, v89
v_cvt_pk_bf16_f32 v89, v90, v91
ds_write_b64 v6, v[88:89] offset:7168
s_waitcnt vmcnt(0)
v_cvt_pk_bf16_f32 v92, v92, v93
v_cvt_pk_bf16_f32 v93, v94, v95
ds_write_b64 v6, v[92:93] offset:7680
v_mov_b32 v10, 163808
s_mov_b32 s46, 0
LBL_l_lw:
ds_read_b32 v9, v10
s_waitcnt lgkmcnt(0)
v_readfirstlane_b32 s3, v9
s_cmp_lg_u32 s3, 0
s_cbranch_scc1 LBL_l_lw_ok
s_sleep 1
s_add_u32 s46, s46, 1
s_cmp_lt_u32 s46, 0x400000
s_cbranch_scc1 LBL_l_lw
LBL_l_lw_ok:
v_lshlrev_b32 v5, 4, v0
s_and_b32 s7, s6, 3
s_lshl_b32 s3, s4, 2
s_add_u32 s3, s3, s7
s_lshl_b32 s3, s3, 15
s_lshr_b32 s7, s6, 2
s_lshl_b32 s7, s7, 14
s_add_u32 s3, s3, s7
s_add_u32 s44, s3, 0x200000
s_add_u32 s45, s44, 0
buffer_load_dwordx4 v[128:131], v5, s[16:19], s45 offen sc1
s_add_u32 s45, s44, 1024
buffer_load_dwordx4 v[132:135], v5, s[16:19], s45 offen sc1
s_add_u32 s45, s44, 2048
buffer_load_dwordx4 v[136:139], v5, s[16:19], s45 offen sc1
s_add_u32 s45, s44, 3072
buffer_load_dwordx4 v[140:143], v5, s[16:19], s45 offen sc1
s_add_u32 s45, s44, 4096
buffer_load_dwordx4 v[144:147], v5, s[16:19], s45 offen sc1
s_add_u32 s45, s44, 5120
buffer_load_dwordx4 v[148:151], v5, s[16:19], s45 offen sc1
s_waitcnt lgkmcnt(0)
s_branch LB_b2
LBL_j7:
LBL_end:
L_exit:
s_endpgm
L_codeend:
.section .rodata,"a"
.p2align 6
.amdhsa_kernel concat_heads__ssm_conv_s5__linear_attn_block__prompt_kernel
  .amdhsa_next_free_vgpr 256
  .amdhsa_next_free_sgpr 102
  .amdhsa_accum_offset 256
  .amdhsa_group_segment_fixed_size 0
  .amdhsa_kernarg_size 120
  .amdhsa_user_sgpr_count 2
  .amdhsa_user_sgpr_kernarg_segment_ptr 1
  .amdhsa_system_sgpr_workgroup_id_x 1
  .amdhsa_float_denorm_mode_32 3
.end_amdhsa_kernel
```
